```python
import torch

def _softmax(x, axis=-1):
    return torch.softmax(x, dim=axis)
def _gelu(x):
    return torch.nn.functional.gelu(x, approximate="tanh")
def _silu(x):
    return torch.nn.functional.silu(x)
def _sigmoid(x):
    return torch.sigmoid(x)
def _layernorm(x, axis=-1, eps=1e-5):
    m = x.mean(dim=axis, keepdim=True)
    v = x.var(dim=axis, keepdim=True, unbiased=False)
    return (x - m) / torch.sqrt(v + eps)
def _scatter_add(tgt, idx, src, axis=0):
    return tgt.clone().index_add_(axis, idx, src)
def _segment_sum(src, seg, n):
    out = torch.zeros((n,) + src.shape[1:], dtype=src.dtype)
    return out.index_add_(0, seg, src)
def _pad(x, pw):
    flat = tuple(v for pair in reversed(pw) for v in pair)
    return torch.nn.functional.pad(x, flat)

kernel_name = 'standalone__molecular_angular_gemnet__graph'

def setup_inputs():

    _w = (lambda a: (lambda t: t.to(torch.bfloat16) if t.is_floating_point() else t)(torch.as_tensor(a)))
    N, deg, De, L = 12500, 32, 16, 3
    E = N * deg
    T = E * deg
    NR = 8
    dist = torch.rand(E).to(float)
    angle = (torch.rand(T) * torch.pi).to(float)
    centers = torch.linspace(0.0, 1.0, NR).to(float)
    ang_freq = torch.arange(1, L + 1).to(float)
    return {
        "m": _w((lambda *s: torch.randn(*s, dtype=torch.bfloat16) * 0.05)(E, De)),
        "idx_in": _w((lambda lo, hi, *s: torch.randint(lo, hi, s))(0, E, T).to(torch.int64)),
        "idx_out": _w((lambda lo, hi, *s: torch.randint(lo, hi, s))(0, E, T).to(torch.int64)),
        "dist": _w(dist),
        "angle": _w(angle),
        "centers": _w(centers),
        "ang_freq": _w(ang_freq),
        "w_rbf": _w((lambda *s: torch.randn(*s, dtype=torch.bfloat16) * 0.2)(NR, De)),
        "w_sbf": _w((lambda *s: torch.randn(*s, dtype=torch.bfloat16) * 0.2)(NR * L, De)),
        "w_down": _w((lambda *s: torch.randn(*s, dtype=torch.bfloat16) * 0.2)(De, De)),
        "w_up": _w((lambda *s: torch.randn(*s, dtype=torch.bfloat16) * 0.2)(De, De)),
    }

def reference(m, idx_in, idx_out, dist, angle, centers, ang_freq, w_rbf, w_sbf, w_down, w_up):
    E, De = m.shape[0], m.shape[1]
    NR = centers.shape[0]
    L = ang_freq.shape[0]
    rbf = torch.exp(-10.0 * (dist[:, None] - centers[None, :]) ** 2)
    cbf = torch.cos(ang_freq[None, :] * angle[:, None])
    rbf_t = rbf[idx_out]
    sbf = torch.reshape(rbf_t[:, :, None] * cbf[:, None, :], (-1, NR * L))
    x = (m[idx_in] @ w_down) * (sbf @ w_sbf)
    agg = _segment_sum(x, idx_out, E)
    return m + (agg @ w_up) * (rbf @ w_rbf)
```

```asm
; @launch kernel=gemnet_part_kernel grid=(256,1,1) block=(1024,1,1) lds=158448
; @launch kernel=standalone__molecular_angular_gemnet__graph_kernel grid=(256,1,1) block=(768,1,1) lds=163840
.amdgcn_target "amdgcn-amd-amdhsa--gfx950"
.text
    .globl gemnet_part_kernel
    .p2align 8
    .type gemnet_part_kernel,@function
gemnet_part_kernel:
    s_cmp_ge_u32 s2, 256
    s_cbranch_scc1 P1_END
    s_load_dwordx4 s[4:7], s[0:1], 8
    s_load_dwordx2 s[28:29], s[0:1], 32
    s_load_dwordx2 s[30:31], s[0:1], 104
    s_load_dwordx2 s[74:75], s[0:1], 0
    s_load_dwordx2 s[62:63], s[0:1], 24
    s_load_dwordx2 s[72:73], s[0:1], 40
    s_load_dwordx4 s[64:67], s[0:1], 56
    s_load_dwordx4 s[68:71], s[0:1], 72
    v_lshlrev_b32 v1, 4, v0
    v_lshlrev_b32 v2, 3, v0
    v_bfrev_b32 v11, 1
    v_cmp_gt_u32 vcc, 106, v0
    s_mov_b32 s32, 2747900
    s_mov_b32 s33, 85899
    s_mov_b32 s34, -1563
    s_mov_b32 s35, 108448
    v_cndmask_b32 v3, v11, v1, vcc
    v_cndmask_b32 v4, v11, v2, vcc
    v_mov_b32 v5, 1
    v_lshlrev_b32 v6, 2, v0
    v_mul_u32_u24 v7, 12, v0
    v_cmp_gt_u32 vcc, 212, v0
    v_lshlrev_b32 v9, 11, v0
    s_nop 0
    v_cndmask_b32 v8, v11, v7, vcc
    v_cmp_eq_u32 vcc, 1023, v0
    v_mov_b32 v12, 2097152
    s_nop 0
    v_cndmask_b32 v10, v11, v12, vcc
    v_lshrrev_b32 v12, 6, v0
    s_nop 0
    v_readfirstlane_b32 s40, v12
    v_mov_b32 v13, 0
    ds_write_b32 v6, v13 offset:0
    ds_write_b32 v6, v13 offset:4096
    s_waitcnt lgkmcnt(0)
    s_mov_b32 s8, s4
    s_and_b32 s9, s5, 0xffff
    s_mov_b32 s10, 51200000
    s_mov_b32 s11, 0x20000
    s_mov_b32 s12, s6
    s_and_b32 s13, s7, 0xffff
    s_mov_b32 s14, 51200000
    s_mov_b32 s15, 0x20000
    s_mov_b32 s16, s28
    s_and_b32 s17, s29, 0xffff
    s_mov_b32 s18, 25600000
    s_mov_b32 s19, 0x20000
    s_mov_b32 s20, s30
    s_and_b32 s21, s31, 0xffff
    s_mov_b32 s22, 76800000
    s_mov_b32 s23, 0x20000
    s_add_u32 s30, s30, 83886080
    s_addc_u32 s31, s31, 0
    s_mov_b32 s24, s30
    s_and_b32 s25, s31, 0xffff
    s_mov_b32 s26, 2098176
    s_mov_b32 s27, 0x20000
    s_mov_b32 s48, s74
    s_and_b32 s49, s75, 0xffff
    s_mov_b32 s50, 12800000
    s_mov_b32 s51, 0x20000
    s_mul_i32 s46, s2, 391
    v_add_u32 v126, s46, v0
    v_lshlrev_b32 v126, 7, v126
    v_cmp_gt_u32 vcc, 391, v0
    s_and_saveexec_b64 s[54:55], vcc
    buffer_load_dword v125, v126, s[48:51], 0 offen
    s_mov_b64 exec, s[54:55]
    s_cmp_lg_u32 s40, 15
    s_cbranch_scc1 P1WD_1
    s_mov_b32 s48, s62
    s_and_b32 s49, s63, 0xffff
    s_mov_b32 s50, 800000
    s_mov_b32 s51, 0x20000
    s_mul_i32 s46, s2, 25
    v_and_b32 v126, 63, v0
    v_add_u32 v126, s46, v126
    v_lshlrev_b32 v126, 7, v126
    s_mov_b64 exec, 0x1ffffff
    buffer_load_dword v125, v126, s[48:51], 0 offen
    s_mov_b64 exec, -1
P1WD_1:
    s_cmp_lg_u32 s40, 14
    s_cbranch_scc1 P1WW_2
    s_cmp_ge_u32 s2, 8
    s_cbranch_scc1 P1WW_2
    v_and_b32 v126, 63, v0
    v_lshlrev_b32 v126, 7, v126
    s_mov_b32 s48, s72
    s_and_b32 s49, s73, 0xffff
    s_mov_b32 s50, 16
    s_mov_b32 s51, 0x20000
    buffer_load_dword v125, v126, s[48:51], 0 offen
    s_mov_b32 s48, s64
    s_and_b32 s49, s65, 0xffff
    s_mov_b32 s50, 256
    s_mov_b32 s51, 0x20000
    buffer_load_dword v125, v126, s[48:51], 0 offen
    s_mov_b32 s48, s66
    s_and_b32 s49, s67, 0xffff
    s_mov_b32 s50, 768
    s_mov_b32 s51, 0x20000
    buffer_load_dword v125, v126, s[48:51], 0 offen
    s_mov_b32 s48, s68
    s_and_b32 s49, s69, 0xffff
    s_mov_b32 s50, 512
    s_mov_b32 s51, 0x20000
    buffer_load_dword v125, v126, s[48:51], 0 offen
    s_mov_b32 s48, s70
    s_and_b32 s49, s71, 0xffff
    s_mov_b32 s50, 512
    s_mov_b32 s51, 0x20000
    buffer_load_dword v125, v126, s[48:51], 0 offen
P1WW_2:
    s_barrier
    s_lshl_b32 s36, s2, 1
    s_mul_i32 s37, s36, 100000
    s_mul_i32 s38, s36, 50000
    s_add_u32 s47, s37, 100000
    s_add_u32 s52, s38, 50000
    s_add_u32 s41, s37, 0
    s_add_u32 s42, s38, 0
    buffer_load_dwordx4 v[24:27], v1, s[12:15], s41 offen nt
    buffer_load_dwordx4 v[28:31], v1, s[8:11], s41 offen nt
    buffer_load_dwordx2 v[32:33], v2, s[16:19], s42 offen nt
    s_add_u32 s41, s37, 16384
    s_add_u32 s42, s38, 8192
    buffer_load_dwordx4 v[34:37], v1, s[12:15], s41 offen nt
    buffer_load_dwordx4 v[38:41], v1, s[8:11], s41 offen nt
    buffer_load_dwordx2 v[42:43], v2, s[16:19], s42 offen nt
    s_add_u32 s41, s37, 32768
    s_add_u32 s42, s38, 16384
    buffer_load_dwordx4 v[44:47], v1, s[12:15], s41 offen nt
    buffer_load_dwordx4 v[48:51], v1, s[8:11], s41 offen nt
    buffer_load_dwordx2 v[52:53], v2, s[16:19], s42 offen nt
    s_add_u32 s41, s37, 49152
    s_add_u32 s42, s38, 24576
    buffer_load_dwordx4 v[54:57], v1, s[12:15], s41 offen nt
    buffer_load_dwordx4 v[58:61], v1, s[8:11], s41 offen nt
    buffer_load_dwordx2 v[62:63], v2, s[16:19], s42 offen nt
    s_add_u32 s41, s37, 65536
    s_add_u32 s42, s38, 32768
    buffer_load_dwordx4 v[64:67], v1, s[12:15], s41 offen nt
    buffer_load_dwordx4 v[68:71], v1, s[8:11], s41 offen nt
    buffer_load_dwordx2 v[72:73], v2, s[16:19], s42 offen nt
    s_add_u32 s41, s37, 81920
    s_add_u32 s42, s38, 40960
    buffer_load_dwordx4 v[74:77], v1, s[12:15], s41 offen nt
    buffer_load_dwordx4 v[78:81], v1, s[8:11], s41 offen nt
    buffer_load_dwordx2 v[82:83], v2, s[16:19], s42 offen nt
    s_add_u32 s41, s37, 98304
    s_add_u32 s42, s38, 49152
    buffer_load_dwordx4 v[84:87], v3, s[12:15], s41 offen nt
    buffer_load_dwordx4 v[88:91], v3, s[8:11], s41 offen nt
    buffer_load_dwordx2 v[92:93], v4, s[16:19], s42 offen nt
    s_waitcnt vmcnt(18)
    v_mul_hi_u32_u24 v12, s32, v24
    v_mul_hi_u32_u24 v13, s33, v28
    v_mad_i32_i24 v14, v12, s34, v24
    v_lshl_add_u32 v13, v13, 8, v12
    v_and_b32 v15, 15, v14
    v_lshlrev_b32 v24, 2, v13
    v_lshl_or_b32 v15, v28, 5, v15
    v_lshrrev_b32 v14, 4, v14
    ds_add_rtn_u32 v94, v24, v5 offset:0
    v_lshl_or_b32 v28, v14, 24, v15
    v_mul_hi_u32_u24 v12, s32, v25
    v_mul_hi_u32_u24 v13, s33, v29
    v_mad_i32_i24 v14, v12, s34, v25
    v_lshl_add_u32 v13, v13, 8, v12
    v_and_b32 v15, 15, v14
    v_lshlrev_b32 v25, 2, v13
    v_lshl_or_b32 v15, v29, 5, v15
    v_lshrrev_b32 v14, 4, v14
    ds_add_rtn_u32 v95, v25, v5 offset:0
    v_lshl_or_b32 v29, v14, 24, v15
    v_mul_hi_u32_u24 v12, s32, v26
    v_mul_hi_u32_u24 v13, s33, v30
    v_mad_i32_i24 v14, v12, s34, v26
    v_lshl_add_u32 v13, v13, 8, v12
    v_and_b32 v15, 15, v14
    v_lshlrev_b32 v26, 2, v13
    v_lshl_or_b32 v15, v30, 5, v15
    v_lshrrev_b32 v14, 4, v14
    ds_add_rtn_u32 v96, v26, v5 offset:0
    v_lshl_or_b32 v30, v14, 24, v15
    v_mul_hi_u32_u24 v12, s32, v27
    v_mul_hi_u32_u24 v13, s33, v31
    v_mad_i32_i24 v14, v12, s34, v27
    v_lshl_add_u32 v13, v13, 8, v12
    v_and_b32 v15, 15, v14
    v_lshlrev_b32 v27, 2, v13
    v_lshl_or_b32 v15, v31, 5, v15
    v_lshrrev_b32 v14, 4, v14
    ds_add_rtn_u32 v97, v27, v5 offset:0
    v_lshl_or_b32 v31, v14, 24, v15
    s_waitcnt vmcnt(15)
    s_waitcnt lgkmcnt(0)
    v_lshl_or_b32 v94, v24, 16, v94
    v_lshl_or_b32 v95, v25, 16, v95
    v_lshl_or_b32 v96, v26, 16, v96
    v_lshl_or_b32 v97, v27, 16, v97
    s_add_u32 s41, s47, 0
    buffer_load_dwordx4 v[24:27], v1, s[12:15], s41 offen nt
    v_mul_hi_u32_u24 v12, s32, v34
    v_mul_hi_u32_u24 v13, s33, v38
    v_mad_i32_i24 v14, v12, s34, v34
    v_lshl_add_u32 v13, v13, 8, v12
    v_and_b32 v15, 15, v14
    v_lshlrev_b32 v34, 2, v13
    v_lshl_or_b32 v15, v38, 5, v15
    v_lshrrev_b32 v14, 4, v14
    ds_add_rtn_u32 v98, v34, v5 offset:0
    v_lshl_or_b32 v38, v14, 24, v15
    v_mul_hi_u32_u24 v12, s32, v35
    v_mul_hi_u32_u24 v13, s33, v39
    v_mad_i32_i24 v14, v12, s34, v35
    v_lshl_add_u32 v13, v13, 8, v12
    v_and_b32 v15, 15, v14
    v_lshlrev_b32 v35, 2, v13
    v_lshl_or_b32 v15, v39, 5, v15
    v_lshrrev_b32 v14, 4, v14
    ds_add_rtn_u32 v99, v35, v5 offset:0
    v_lshl_or_b32 v39, v14, 24, v15
    v_mul_hi_u32_u24 v12, s32, v36
    v_mul_hi_u32_u24 v13, s33, v40
    v_mad_i32_i24 v14, v12, s34, v36
    v_lshl_add_u32 v13, v13, 8, v12
    v_and_b32 v15, 15, v14
    v_lshlrev_b32 v36, 2, v13
    v_lshl_or_b32 v15, v40, 5, v15
    v_lshrrev_b32 v14, 4, v14
    ds_add_rtn_u32 v100, v36, v5 offset:0
    v_lshl_or_b32 v40, v14, 24, v15
    v_mul_hi_u32_u24 v12, s32, v37
    v_mul_hi_u32_u24 v13, s33, v41
    v_mad_i32_i24 v14, v12, s34, v37
    v_lshl_add_u32 v13, v13, 8, v12
    v_and_b32 v15, 15, v14
    v_lshlrev_b32 v37, 2, v13
    v_lshl_or_b32 v15, v41, 5, v15
    v_lshrrev_b32 v14, 4, v14
    ds_add_rtn_u32 v101, v37, v5 offset:0
    v_lshl_or_b32 v41, v14, 24, v15
    s_waitcnt vmcnt(13)
    s_waitcnt lgkmcnt(0)
    v_lshl_or_b32 v98, v34, 16, v98
    v_lshl_or_b32 v99, v35, 16, v99
    v_lshl_or_b32 v100, v36, 16, v100
    v_lshl_or_b32 v101, v37, 16, v101
    s_add_u32 s41, s47, 16384
    buffer_load_dwordx4 v[34:37], v1, s[12:15], s41 offen nt
    v_mul_hi_u32_u24 v12, s32, v44
    v_mul_hi_u32_u24 v13, s33, v48
    v_mad_i32_i24 v14, v12, s34, v44
    v_lshl_add_u32 v13, v13, 8, v12
    v_and_b32 v15, 15, v14
    v_lshlrev_b32 v44, 2, v13
    v_lshl_or_b32 v15, v48, 5, v15
    v_lshrrev_b32 v14, 4, v14
    ds_add_rtn_u32 v102, v44, v5 offset:0
    v_lshl_or_b32 v48, v14, 24, v15
    v_mul_hi_u32_u24 v12, s32, v45
    v_mul_hi_u32_u24 v13, s33, v49
    v_mad_i32_i24 v14, v12, s34, v45
    v_lshl_add_u32 v13, v13, 8, v12
    v_and_b32 v15, 15, v14
    v_lshlrev_b32 v45, 2, v13
    v_lshl_or_b32 v15, v49, 5, v15
    v_lshrrev_b32 v14, 4, v14
    ds_add_rtn_u32 v103, v45, v5 offset:0
    v_lshl_or_b32 v49, v14, 24, v15
    v_mul_hi_u32_u24 v12, s32, v46
    v_mul_hi_u32_u24 v13, s33, v50
    v_mad_i32_i24 v14, v12, s34, v46
    v_lshl_add_u32 v13, v13, 8, v12
    v_and_b32 v15, 15, v14
    v_lshlrev_b32 v46, 2, v13
    v_lshl_or_b32 v15, v50, 5, v15
    v_lshrrev_b32 v14, 4, v14
    ds_add_rtn_u32 v104, v46, v5 offset:0
    v_lshl_or_b32 v50, v14, 24, v15
    v_mul_hi_u32_u24 v12, s32, v47
    v_mul_hi_u32_u24 v13, s33, v51
    v_mad_i32_i24 v14, v12, s34, v47
    v_lshl_add_u32 v13, v13, 8, v12
    v_and_b32 v15, 15, v14
    v_lshlrev_b32 v47, 2, v13
    v_lshl_or_b32 v15, v51, 5, v15
    v_lshrrev_b32 v14, 4, v14
    ds_add_rtn_u32 v105, v47, v5 offset:0
    v_lshl_or_b32 v51, v14, 24, v15
    s_waitcnt vmcnt(11)
    s_waitcnt lgkmcnt(0)
    v_lshl_or_b32 v102, v44, 16, v102
    v_lshl_or_b32 v103, v45, 16, v103
    v_lshl_or_b32 v104, v46, 16, v104
    v_lshl_or_b32 v105, v47, 16, v105
    s_add_u32 s41, s47, 32768
    buffer_load_dwordx4 v[44:47], v1, s[12:15], s41 offen nt
    v_mul_hi_u32_u24 v12, s32, v54
    v_mul_hi_u32_u24 v13, s33, v58
    v_mad_i32_i24 v14, v12, s34, v54
    v_lshl_add_u32 v13, v13, 8, v12
    v_and_b32 v15, 15, v14
    v_lshlrev_b32 v54, 2, v13
    v_lshl_or_b32 v15, v58, 5, v15
    v_lshrrev_b32 v14, 4, v14
    ds_add_rtn_u32 v106, v54, v5 offset:0
    v_lshl_or_b32 v58, v14, 24, v15
    v_mul_hi_u32_u24 v12, s32, v55
    v_mul_hi_u32_u24 v13, s33, v59
    v_mad_i32_i24 v14, v12, s34, v55
    v_lshl_add_u32 v13, v13, 8, v12
    v_and_b32 v15, 15, v14
    v_lshlrev_b32 v55, 2, v13
    v_lshl_or_b32 v15, v59, 5, v15
    v_lshrrev_b32 v14, 4, v14
    ds_add_rtn_u32 v107, v55, v5 offset:0
    v_lshl_or_b32 v59, v14, 24, v15
    v_mul_hi_u32_u24 v12, s32, v56
    v_mul_hi_u32_u24 v13, s33, v60
    v_mad_i32_i24 v14, v12, s34, v56
    v_lshl_add_u32 v13, v13, 8, v12
    v_and_b32 v15, 15, v14
    v_lshlrev_b32 v56, 2, v13
    v_lshl_or_b32 v15, v60, 5, v15
    v_lshrrev_b32 v14, 4, v14
    ds_add_rtn_u32 v108, v56, v5 offset:0
    v_lshl_or_b32 v60, v14, 24, v15
    v_mul_hi_u32_u24 v12, s32, v57
    v_mul_hi_u32_u24 v13, s33, v61
    v_mad_i32_i24 v14, v12, s34, v57
    v_lshl_add_u32 v13, v13, 8, v12
    v_and_b32 v15, 15, v14
    v_lshlrev_b32 v57, 2, v13
    v_lshl_or_b32 v15, v61, 5, v15
    v_lshrrev_b32 v14, 4, v14
    ds_add_rtn_u32 v109, v57, v5 offset:0
    v_lshl_or_b32 v61, v14, 24, v15
    s_waitcnt vmcnt(9)
    s_waitcnt lgkmcnt(0)
    v_lshl_or_b32 v106, v54, 16, v106
    v_lshl_or_b32 v107, v55, 16, v107
    v_lshl_or_b32 v108, v56, 16, v108
    v_lshl_or_b32 v109, v57, 16, v109
    s_add_u32 s41, s47, 49152
    buffer_load_dwordx4 v[54:57], v1, s[12:15], s41 offen nt
    v_mul_hi_u32_u24 v12, s32, v64
    v_mul_hi_u32_u24 v13, s33, v68
    v_mad_i32_i24 v14, v12, s34, v64
    v_lshl_add_u32 v13, v13, 8, v12
    v_and_b32 v15, 15, v14
    v_lshlrev_b32 v64, 2, v13
    v_lshl_or_b32 v15, v68, 5, v15
    v_lshrrev_b32 v14, 4, v14
    ds_add_rtn_u32 v110, v64, v5 offset:0
    v_lshl_or_b32 v68, v14, 24, v15
    v_mul_hi_u32_u24 v12, s32, v65
    v_mul_hi_u32_u24 v13, s33, v69
    v_mad_i32_i24 v14, v12, s34, v65
    v_lshl_add_u32 v13, v13, 8, v12
    v_and_b32 v15, 15, v14
    v_lshlrev_b32 v65, 2, v13
    v_lshl_or_b32 v15, v69, 5, v15
    v_lshrrev_b32 v14, 4, v14
    ds_add_rtn_u32 v111, v65, v5 offset:0
    v_lshl_or_b32 v69, v14, 24, v15
    v_mul_hi_u32_u24 v12, s32, v66
    v_mul_hi_u32_u24 v13, s33, v70
    v_mad_i32_i24 v14, v12, s34, v66
    v_lshl_add_u32 v13, v13, 8, v12
    v_and_b32 v15, 15, v14
    v_lshlrev_b32 v66, 2, v13
    v_lshl_or_b32 v15, v70, 5, v15
    v_lshrrev_b32 v14, 4, v14
    ds_add_rtn_u32 v112, v66, v5 offset:0
    v_lshl_or_b32 v70, v14, 24, v15
    v_mul_hi_u32_u24 v12, s32, v67
    v_mul_hi_u32_u24 v13, s33, v71
    v_mad_i32_i24 v14, v12, s34, v67
    v_lshl_add_u32 v13, v13, 8, v12
    v_and_b32 v15, 15, v14
    v_lshlrev_b32 v67, 2, v13
    v_lshl_or_b32 v15, v71, 5, v15
    v_lshrrev_b32 v14, 4, v14
    ds_add_rtn_u32 v113, v67, v5 offset:0
    v_lshl_or_b32 v71, v14, 24, v15
    s_waitcnt vmcnt(7)
    s_waitcnt lgkmcnt(0)
    v_lshl_or_b32 v110, v64, 16, v110
    v_lshl_or_b32 v111, v65, 16, v111
    v_lshl_or_b32 v112, v66, 16, v112
    v_lshl_or_b32 v113, v67, 16, v113
    s_add_u32 s41, s47, 65536
    buffer_load_dwordx4 v[64:67], v1, s[12:15], s41 offen nt
    v_mul_hi_u32_u24 v12, s32, v74
    v_mul_hi_u32_u24 v13, s33, v78
    v_mad_i32_i24 v14, v12, s34, v74
    v_lshl_add_u32 v13, v13, 8, v12
    v_and_b32 v15, 15, v14
    v_lshlrev_b32 v74, 2, v13
    v_lshl_or_b32 v15, v78, 5, v15
    v_lshrrev_b32 v14, 4, v14
    ds_add_rtn_u32 v114, v74, v5 offset:0
    v_lshl_or_b32 v78, v14, 24, v15
    v_mul_hi_u32_u24 v12, s32, v75
    v_mul_hi_u32_u24 v13, s33, v79
    v_mad_i32_i24 v14, v12, s34, v75
    v_lshl_add_u32 v13, v13, 8, v12
    v_and_b32 v15, 15, v14
    v_lshlrev_b32 v75, 2, v13
    v_lshl_or_b32 v15, v79, 5, v15
    v_lshrrev_b32 v14, 4, v14
    ds_add_rtn_u32 v115, v75, v5 offset:0
    v_lshl_or_b32 v79, v14, 24, v15
    v_mul_hi_u32_u24 v12, s32, v76
    v_mul_hi_u32_u24 v13, s33, v80
    v_mad_i32_i24 v14, v12, s34, v76
    v_lshl_add_u32 v13, v13, 8, v12
    v_and_b32 v15, 15, v14
    v_lshlrev_b32 v76, 2, v13
    v_lshl_or_b32 v15, v80, 5, v15
    v_lshrrev_b32 v14, 4, v14
    ds_add_rtn_u32 v116, v76, v5 offset:0
    v_lshl_or_b32 v80, v14, 24, v15
    v_mul_hi_u32_u24 v12, s32, v77
    v_mul_hi_u32_u24 v13, s33, v81
    v_mad_i32_i24 v14, v12, s34, v77
    v_lshl_add_u32 v13, v13, 8, v12
    v_and_b32 v15, 15, v14
    v_lshlrev_b32 v77, 2, v13
    v_lshl_or_b32 v15, v81, 5, v15
    v_lshrrev_b32 v14, 4, v14
    ds_add_rtn_u32 v117, v77, v5 offset:0
    v_lshl_or_b32 v81, v14, 24, v15
    s_waitcnt vmcnt(5)
    s_waitcnt lgkmcnt(0)
    v_lshl_or_b32 v114, v74, 16, v114
    v_lshl_or_b32 v115, v75, 16, v115
    v_lshl_or_b32 v116, v76, 16, v116
    v_lshl_or_b32 v117, v77, 16, v117
    s_add_u32 s41, s47, 81920
    buffer_load_dwordx4 v[74:77], v1, s[12:15], s41 offen nt
    v_cmp_gt_u32 vcc, 106, v0
    s_and_saveexec_b64 s[44:45], vcc
    s_cbranch_execz P1_SKIPQ_3
    v_mul_hi_u32_u24 v12, s32, v84
    v_mul_hi_u32_u24 v13, s33, v88
    v_mad_i32_i24 v14, v12, s34, v84
    v_lshl_add_u32 v13, v13, 8, v12
    v_and_b32 v15, 15, v14
    v_lshlrev_b32 v84, 2, v13
    v_lshl_or_b32 v15, v88, 5, v15
    v_lshrrev_b32 v14, 4, v14
    ds_add_rtn_u32 v118, v84, v5 offset:0
    v_lshl_or_b32 v88, v14, 24, v15
    v_mul_hi_u32_u24 v12, s32, v85
    v_mul_hi_u32_u24 v13, s33, v89
    v_mad_i32_i24 v14, v12, s34, v85
    v_lshl_add_u32 v13, v13, 8, v12
    v_and_b32 v15, 15, v14
    v_lshlrev_b32 v85, 2, v13
    v_lshl_or_b32 v15, v89, 5, v15
    v_lshrrev_b32 v14, 4, v14
    ds_add_rtn_u32 v119, v85, v5 offset:0
    v_lshl_or_b32 v89, v14, 24, v15
    v_mul_hi_u32_u24 v12, s32, v86
    v_mul_hi_u32_u24 v13, s33, v90
    v_mad_i32_i24 v14, v12, s34, v86
    v_lshl_add_u32 v13, v13, 8, v12
    v_and_b32 v15, 15, v14
    v_lshlrev_b32 v86, 2, v13
    v_lshl_or_b32 v15, v90, 5, v15
    v_lshrrev_b32 v14, 4, v14
    ds_add_rtn_u32 v120, v86, v5 offset:0
    v_lshl_or_b32 v90, v14, 24, v15
    v_mul_hi_u32_u24 v12, s32, v87
    v_mul_hi_u32_u24 v13, s33, v91
    v_mad_i32_i24 v14, v12, s34, v87
    v_lshl_add_u32 v13, v13, 8, v12
    v_and_b32 v15, 15, v14
    v_lshlrev_b32 v87, 2, v13
    v_lshl_or_b32 v15, v91, 5, v15
    v_lshrrev_b32 v14, 4, v14
    ds_add_rtn_u32 v121, v87, v5 offset:0
    v_lshl_or_b32 v91, v14, 24, v15
P1_SKIPQ_3:
    s_mov_b64 exec, s[44:45]
    s_waitcnt lgkmcnt(0)
    v_lshl_or_b32 v118, v84, 16, v118
    v_lshl_or_b32 v119, v85, 16, v119
    v_lshl_or_b32 v120, v86, 16, v120
    v_lshl_or_b32 v121, v87, 16, v121
    s_add_u32 s41, s47, 98304
    buffer_load_dwordx4 v[84:87], v3, s[12:15], s41 offen nt
    s_barrier
    v_lshlrev_b32 v18, 3, v0
    ds_read_b64 v[16:17], v18
    v_lshrrev_b32 v15, 4, v0
    v_and_b32 v15, 0xfc, v15
    s_waitcnt lgkmcnt(0)
    v_add_u32 v13, v16, v17
    v_mov_b32 v12, v13
    s_nop 1
    v_add_u32_dpp v12, v12, v12 row_shr:1 row_mask:0xf bank_mask:0xf
    s_nop 1
    v_add_u32_dpp v12, v12, v12 row_shr:2 row_mask:0xf bank_mask:0xf
    s_nop 1
    v_add_u32_dpp v12, v12, v12 row_shr:4 row_mask:0xf bank_mask:0xf
    s_nop 1
    v_add_u32_dpp v12, v12, v12 row_shr:8 row_mask:0xf bank_mask:0xf
    s_nop 1
    v_add_u32_dpp v12, v12, v12 row_bcast:15 row_mask:0xa bank_mask:0xf
    s_nop 1
    v_add_u32_dpp v12, v12, v12 row_bcast:31 row_mask:0xc bank_mask:0xf
    s_mov_b32 exec_lo, 0
    s_brev_b32 exec_hi, 1
    ds_write_b32 v15, v12 offset:8192
    s_mov_b64 exec, -1
    s_waitcnt lgkmcnt(0)
    s_barrier
    v_and_b32 v14, 15, v0
    v_lshlrev_b32 v14, 2, v14
    ds_read_b32 v14, v14 offset:8192
    s_waitcnt lgkmcnt(0)
    v_mov_b32 v15, v14
    s_nop 1
    v_add_u32_dpp v15, v15, v15 row_shr:1 row_mask:0xf bank_mask:0xf
    s_nop 1
    v_add_u32_dpp v15, v15, v15 row_shr:2 row_mask:0xf bank_mask:0xf
    s_nop 1
    v_add_u32_dpp v15, v15, v15 row_shr:4 row_mask:0xf bank_mask:0xf
    s_nop 1
    v_add_u32_dpp v15, v15, v15 row_shr:8 row_mask:0xf bank_mask:0xf
    v_sub_u32 v15, v15, v14
    s_nop 0
    v_readlane_b32 s43, v15, s40
    v_sub_u32 v14, v12, v13
    s_nop 1
    v_add_u32 v14, s43, v14
    v_add_u32 v12, s43, v12
    s_lshl_b32 s41, s36, 1
    v_add_u32 v17, v14, v16
    v_mov_b32 v16, v14
    ds_write_b64 v18, v[16:17]
    v_mov_b32 v122, v16
    v_mov_b32 v123, v17
    v_mov_b32 v124, v12
    s_waitcnt lgkmcnt(0)
    s_barrier
    s_mul_i32 s39, s36, 150000
    v_lshrrev_b32 v12, 16, v94
    v_lshrrev_b32 v13, 16, v95
    v_lshrrev_b32 v14, 16, v96
    v_lshrrev_b32 v15, 16, v97
    ds_read_b32 v12, v12 offset:0
    ds_read_b32 v13, v13 offset:0
    ds_read_b32 v14, v14 offset:0
    ds_read_b32 v15, v15 offset:0
    v_lshrrev_b32 v16, 16, v98
    v_lshrrev_b32 v17, 16, v99
    v_lshrrev_b32 v18, 16, v100
    v_lshrrev_b32 v19, 16, v101
    ds_read_b32 v16, v16 offset:0
    ds_read_b32 v17, v17 offset:0
    ds_read_b32 v18, v18 offset:0
    ds_read_b32 v19, v19 offset:0
    s_waitcnt lgkmcnt(4)
    v_add_u32_sdwa v12, v12, v94 dst_sel:DWORD dst_unused:UNUSED_PAD src0_sel:DWORD src1_sel:WORD_0
    v_lshlrev_b32 v20, 2, v12
    v_lshl_add_u32 v21, v12, 1, s35
    ds_write_b32 v20, v28 offset:8448
    ds_write_b16 v21, v32
    v_add_u32_sdwa v13, v13, v95 dst_sel:DWORD dst_unused:UNUSED_PAD src0_sel:DWORD src1_sel:WORD_0
    v_lshlrev_b32 v20, 2, v13
    v_lshl_add_u32 v21, v13, 1, s35
    ds_write_b32 v20, v29 offset:8448
    ds_write_b16_d16_hi v21, v32
    v_add_u32_sdwa v14, v14, v96 dst_sel:DWORD dst_unused:UNUSED_PAD src0_sel:DWORD src1_sel:WORD_0
    v_lshlrev_b32 v20, 2, v14
    v_lshl_add_u32 v21, v14, 1, s35
    ds_write_b32 v20, v30 offset:8448
    ds_write_b16 v21, v33
    v_add_u32_sdwa v15, v15, v97 dst_sel:DWORD dst_unused:UNUSED_PAD src0_sel:DWORD src1_sel:WORD_0
    v_lshlrev_b32 v20, 2, v15
    v_lshl_add_u32 v21, v15, 1, s35
    ds_write_b32 v20, v31 offset:8448
    ds_write_b16_d16_hi v21, v33
    s_add_u32 s41, s47, 0
    s_add_u32 s42, s52, 0
    buffer_load_dwordx4 v[28:31], v1, s[8:11], s41 offen nt
    buffer_load_dwordx2 v[32:33], v2, s[16:19], s42 offen nt
    v_lshrrev_b32 v12, 16, v102
    v_lshrrev_b32 v13, 16, v103
    v_lshrrev_b32 v14, 16, v104
    v_lshrrev_b32 v15, 16, v105
    ds_read_b32 v12, v12 offset:0
    ds_read_b32 v13, v13 offset:0
    ds_read_b32 v14, v14 offset:0
    ds_read_b32 v15, v15 offset:0
    s_waitcnt lgkmcnt(4)
    v_add_u32_sdwa v16, v16, v98 dst_sel:DWORD dst_unused:UNUSED_PAD src0_sel:DWORD src1_sel:WORD_0
    v_lshlrev_b32 v20, 2, v16
    v_lshl_add_u32 v21, v16, 1, s35
    ds_write_b32 v20, v38 offset:8448
    ds_write_b16 v21, v42
    v_add_u32_sdwa v17, v17, v99 dst_sel:DWORD dst_unused:UNUSED_PAD src0_sel:DWORD src1_sel:WORD_0
    v_lshlrev_b32 v20, 2, v17
    v_lshl_add_u32 v21, v17, 1, s35
    ds_write_b32 v20, v39 offset:8448
    ds_write_b16_d16_hi v21, v42
    v_add_u32_sdwa v18, v18, v100 dst_sel:DWORD dst_unused:UNUSED_PAD src0_sel:DWORD src1_sel:WORD_0
    v_lshlrev_b32 v20, 2, v18
    v_lshl_add_u32 v21, v18, 1, s35
    ds_write_b32 v20, v40 offset:8448
    ds_write_b16 v21, v43
    v_add_u32_sdwa v19, v19, v101 dst_sel:DWORD dst_unused:UNUSED_PAD src0_sel:DWORD src1_sel:WORD_0
    v_lshlrev_b32 v20, 2, v19
    v_lshl_add_u32 v21, v19, 1, s35
    ds_write_b32 v20, v41 offset:8448
    ds_write_b16_d16_hi v21, v43
    s_add_u32 s41, s47, 16384
    s_add_u32 s42, s52, 8192
    buffer_load_dwordx4 v[38:41], v1, s[8:11], s41 offen nt
    buffer_load_dwordx2 v[42:43], v2, s[16:19], s42 offen nt
    v_lshrrev_b32 v16, 16, v106
    v_lshrrev_b32 v17, 16, v107
    v_lshrrev_b32 v18, 16, v108
    v_lshrrev_b32 v19, 16, v109
    ds_read_b32 v16, v16 offset:0
    ds_read_b32 v17, v17 offset:0
    ds_read_b32 v18, v18 offset:0
    ds_read_b32 v19, v19 offset:0
    s_waitcnt lgkmcnt(4)
    v_add_u32_sdwa v12, v12, v102 dst_sel:DWORD dst_unused:UNUSED_PAD src0_sel:DWORD src1_sel:WORD_0
    v_lshlrev_b32 v20, 2, v12
    v_lshl_add_u32 v21, v12, 1, s35
    ds_write_b32 v20, v48 offset:8448
    ds_write_b16 v21, v52
    v_add_u32_sdwa v13, v13, v103 dst_sel:DWORD dst_unused:UNUSED_PAD src0_sel:DWORD src1_sel:WORD_0
    v_lshlrev_b32 v20, 2, v13
    v_lshl_add_u32 v21, v13, 1, s35
    ds_write_b32 v20, v49 offset:8448
    ds_write_b16_d16_hi v21, v52
    v_add_u32_sdwa v14, v14, v104 dst_sel:DWORD dst_unused:UNUSED_PAD src0_sel:DWORD src1_sel:WORD_0
    v_lshlrev_b32 v20, 2, v14
    v_lshl_add_u32 v21, v14, 1, s35
    ds_write_b32 v20, v50 offset:8448
    ds_write_b16 v21, v53
    v_add_u32_sdwa v15, v15, v105 dst_sel:DWORD dst_unused:UNUSED_PAD src0_sel:DWORD src1_sel:WORD_0
    v_lshlrev_b32 v20, 2, v15
    v_lshl_add_u32 v21, v15, 1, s35
    ds_write_b32 v20, v51 offset:8448
    ds_write_b16_d16_hi v21, v53
    s_add_u32 s41, s47, 32768
    s_add_u32 s42, s52, 16384
    buffer_load_dwordx4 v[48:51], v1, s[8:11], s41 offen nt
    buffer_load_dwordx2 v[52:53], v2, s[16:19], s42 offen nt
    v_lshrrev_b32 v12, 16, v110
    v_lshrrev_b32 v13, 16, v111
    v_lshrrev_b32 v14, 16, v112
    v_lshrrev_b32 v15, 16, v113
    ds_read_b32 v12, v12 offset:0
    ds_read_b32 v13, v13 offset:0
    ds_read_b32 v14, v14 offset:0
    ds_read_b32 v15, v15 offset:0
    s_waitcnt lgkmcnt(4)
    v_add_u32_sdwa v16, v16, v106 dst_sel:DWORD dst_unused:UNUSED_PAD src0_sel:DWORD src1_sel:WORD_0
    v_lshlrev_b32 v20, 2, v16
    v_lshl_add_u32 v21, v16, 1, s35
    ds_write_b32 v20, v58 offset:8448
    ds_write_b16 v21, v62
    v_add_u32_sdwa v17, v17, v107 dst_sel:DWORD dst_unused:UNUSED_PAD src0_sel:DWORD src1_sel:WORD_0
    v_lshlrev_b32 v20, 2, v17
    v_lshl_add_u32 v21, v17, 1, s35
    ds_write_b32 v20, v59 offset:8448
    ds_write_b16_d16_hi v21, v62
    v_add_u32_sdwa v18, v18, v108 dst_sel:DWORD dst_unused:UNUSED_PAD src0_sel:DWORD src1_sel:WORD_0
    v_lshlrev_b32 v20, 2, v18
    v_lshl_add_u32 v21, v18, 1, s35
    ds_write_b32 v20, v60 offset:8448
    ds_write_b16 v21, v63
    v_add_u32_sdwa v19, v19, v109 dst_sel:DWORD dst_unused:UNUSED_PAD src0_sel:DWORD src1_sel:WORD_0
    v_lshlrev_b32 v20, 2, v19
    v_lshl_add_u32 v21, v19, 1, s35
    ds_write_b32 v20, v61 offset:8448
    ds_write_b16_d16_hi v21, v63
    s_add_u32 s41, s47, 49152
    s_add_u32 s42, s52, 24576
    buffer_load_dwordx4 v[58:61], v1, s[8:11], s41 offen nt
    buffer_load_dwordx2 v[62:63], v2, s[16:19], s42 offen nt
    v_lshrrev_b32 v16, 16, v114
    v_lshrrev_b32 v17, 16, v115
    v_lshrrev_b32 v18, 16, v116
    v_lshrrev_b32 v19, 16, v117
    ds_read_b32 v16, v16 offset:0
    ds_read_b32 v17, v17 offset:0
    ds_read_b32 v18, v18 offset:0
    ds_read_b32 v19, v19 offset:0
    s_waitcnt lgkmcnt(4)
    v_add_u32_sdwa v12, v12, v110 dst_sel:DWORD dst_unused:UNUSED_PAD src0_sel:DWORD src1_sel:WORD_0
    v_lshlrev_b32 v20, 2, v12
    v_lshl_add_u32 v21, v12, 1, s35
    ds_write_b32 v20, v68 offset:8448
    ds_write_b16 v21, v72
    v_add_u32_sdwa v13, v13, v111 dst_sel:DWORD dst_unused:UNUSED_PAD src0_sel:DWORD src1_sel:WORD_0
    v_lshlrev_b32 v20, 2, v13
    v_lshl_add_u32 v21, v13, 1, s35
    ds_write_b32 v20, v69 offset:8448
    ds_write_b16_d16_hi v21, v72
    v_add_u32_sdwa v14, v14, v112 dst_sel:DWORD dst_unused:UNUSED_PAD src0_sel:DWORD src1_sel:WORD_0
    v_lshlrev_b32 v20, 2, v14
    v_lshl_add_u32 v21, v14, 1, s35
    ds_write_b32 v20, v70 offset:8448
    ds_write_b16 v21, v73
    v_add_u32_sdwa v15, v15, v113 dst_sel:DWORD dst_unused:UNUSED_PAD src0_sel:DWORD src1_sel:WORD_0
    v_lshlrev_b32 v20, 2, v15
    v_lshl_add_u32 v21, v15, 1, s35
    ds_write_b32 v20, v71 offset:8448
    ds_write_b16_d16_hi v21, v73
    s_add_u32 s41, s47, 65536
    s_add_u32 s42, s52, 32768
    buffer_load_dwordx4 v[68:71], v1, s[8:11], s41 offen nt
    buffer_load_dwordx2 v[72:73], v2, s[16:19], s42 offen nt
    v_cmp_gt_u32 vcc, 106, v0
    s_and_saveexec_b64 s[44:45], vcc
    s_cbranch_execz P1_SKIPQ_4
    v_lshrrev_b32 v12, 16, v118
    v_lshrrev_b32 v13, 16, v119
    v_lshrrev_b32 v14, 16, v120
    v_lshrrev_b32 v15, 16, v121
    ds_read_b32 v12, v12 offset:0
    ds_read_b32 v13, v13 offset:0
    ds_read_b32 v14, v14 offset:0
    ds_read_b32 v15, v15 offset:0
P1_SKIPQ_4:
    s_mov_b64 exec, s[44:45]
    s_waitcnt lgkmcnt(0)
    v_add_u32_sdwa v16, v16, v114 dst_sel:DWORD dst_unused:UNUSED_PAD src0_sel:DWORD src1_sel:WORD_0
    v_lshlrev_b32 v20, 2, v16
    v_lshl_add_u32 v21, v16, 1, s35
    ds_write_b32 v20, v78 offset:8448
    ds_write_b16 v21, v82
    v_add_u32_sdwa v17, v17, v115 dst_sel:DWORD dst_unused:UNUSED_PAD src0_sel:DWORD src1_sel:WORD_0
    v_lshlrev_b32 v20, 2, v17
    v_lshl_add_u32 v21, v17, 1, s35
    ds_write_b32 v20, v79 offset:8448
    ds_write_b16_d16_hi v21, v82
    v_add_u32_sdwa v18, v18, v116 dst_sel:DWORD dst_unused:UNUSED_PAD src0_sel:DWORD src1_sel:WORD_0
    v_lshlrev_b32 v20, 2, v18
    v_lshl_add_u32 v21, v18, 1, s35
    ds_write_b32 v20, v80 offset:8448
    ds_write_b16 v21, v83
    v_add_u32_sdwa v19, v19, v117 dst_sel:DWORD dst_unused:UNUSED_PAD src0_sel:DWORD src1_sel:WORD_0
    v_lshlrev_b32 v20, 2, v19
    v_lshl_add_u32 v21, v19, 1, s35
    ds_write_b32 v20, v81 offset:8448
    ds_write_b16_d16_hi v21, v83
    s_add_u32 s41, s47, 81920
    s_add_u32 s42, s52, 40960
    buffer_load_dwordx4 v[78:81], v1, s[8:11], s41 offen nt
    buffer_load_dwordx2 v[82:83], v2, s[16:19], s42 offen nt
    s_waitcnt lgkmcnt(0)
    v_cmp_gt_u32 vcc, 106, v0
    s_and_saveexec_b64 s[44:45], vcc
    s_cbranch_execz P1_SKIPQ_5
    v_add_u32_sdwa v12, v12, v118 dst_sel:DWORD dst_unused:UNUSED_PAD src0_sel:DWORD src1_sel:WORD_0
    v_lshlrev_b32 v20, 2, v12
    v_lshl_add_u32 v21, v12, 1, s35
    ds_write_b32 v20, v88 offset:8448
    ds_write_b16 v21, v92
    v_add_u32_sdwa v13, v13, v119 dst_sel:DWORD dst_unused:UNUSED_PAD src0_sel:DWORD src1_sel:WORD_0
    v_lshlrev_b32 v20, 2, v13
    v_lshl_add_u32 v21, v13, 1, s35
    ds_write_b32 v20, v89 offset:8448
    ds_write_b16_d16_hi v21, v92
    v_add_u32_sdwa v14, v14, v120 dst_sel:DWORD dst_unused:UNUSED_PAD src0_sel:DWORD src1_sel:WORD_0
    v_lshlrev_b32 v20, 2, v14
    v_lshl_add_u32 v21, v14, 1, s35
    ds_write_b32 v20, v90 offset:8448
    ds_write_b16 v21, v93
    v_add_u32_sdwa v15, v15, v121 dst_sel:DWORD dst_unused:UNUSED_PAD src0_sel:DWORD src1_sel:WORD_0
    v_lshlrev_b32 v20, 2, v15
    v_lshl_add_u32 v21, v15, 1, s35
    ds_write_b32 v20, v91 offset:8448
    ds_write_b16_d16_hi v21, v93
P1_SKIPQ_5:
    s_mov_b64 exec, s[44:45]
    s_add_u32 s41, s47, 98304
    s_add_u32 s42, s52, 49152
    buffer_load_dwordx4 v[88:91], v3, s[8:11], s41 offen nt
    buffer_load_dwordx2 v[92:93], v4, s[16:19], s42 offen nt
    s_waitcnt lgkmcnt(0)
    s_barrier
    v_lshlrev_b32 v18, 3, v0
    v_mov_b32 v16, 0
    v_mov_b32 v17, 0
    ds_write_b64 v18, v[16:17]
    s_waitcnt lgkmcnt(0)
    s_barrier
    v_lshlrev_b32 v12, 3, v0
    v_add_u32 v12, 8448, v12
    v_add_u32 v13, s35, v6
    ds_read_b64 v[94:95], v12 offset:0
    ds_read_b32 v96, v13 offset:0
    ds_read_b64 v[98:99], v12 offset:8192
    ds_read_b32 v100, v13 offset:4096
    ds_read_b64 v[102:103], v12 offset:16384
    ds_read_b32 v104, v13 offset:8192
    ds_read_b64 v[106:107], v12 offset:24576
    ds_read_b32 v108, v13 offset:12288
    ds_read_b64 v[110:111], v12 offset:32768
    ds_read_b32 v112, v13 offset:16384
    ds_read_b64 v[114:115], v12 offset:40960
    ds_read_b32 v116, v13 offset:20480
    ds_read_b64 v[118:119], v12 offset:49152
    ds_read_b32 v120, v13 offset:24576
    s_waitcnt lgkmcnt(12)
    s_add_u32 s41, s39, 0
    buffer_store_dwordx3 v[94:96], v7, s[20:23], s41 offen
    s_waitcnt lgkmcnt(10)
    s_add_u32 s41, s39, 12288
    buffer_store_dwordx3 v[98:100], v7, s[20:23], s41 offen
    s_waitcnt lgkmcnt(8)
    s_add_u32 s41, s39, 24576
    buffer_store_dwordx3 v[102:104], v7, s[20:23], s41 offen
    s_waitcnt lgkmcnt(6)
    s_add_u32 s41, s39, 36864
    buffer_store_dwordx3 v[106:108], v7, s[20:23], s41 offen
    s_waitcnt lgkmcnt(4)
    s_add_u32 s41, s39, 49152
    buffer_store_dwordx3 v[110:112], v7, s[20:23], s41 offen
    s_waitcnt lgkmcnt(2)
    s_add_u32 s41, s39, 61440
    buffer_store_dwordx3 v[114:116], v7, s[20:23], s41 offen
    s_waitcnt lgkmcnt(0)
    s_add_u32 s41, s39, 73728
    buffer_store_dwordx3 v[118:120], v7, s[20:23], s41 offen
    s_nop 1
    ds_read_b64 v[94:95], v12 offset:57344
    ds_read_b32 v96, v13 offset:28672
    v_add_u32 v14, 65536, v12
    ds_read_b64 v[98:99], v14
    ds_read_b32 v100, v13 offset:32768
    v_add_u32 v14, 73728, v12
    ds_read_b64 v[102:103], v14
    ds_read_b32 v104, v13 offset:36864
    v_add_u32 v14, 81920, v12
    ds_read_b64 v[106:107], v14
    ds_read_b32 v108, v13 offset:40960
    v_add_u32 v14, 90112, v12
    ds_read_b64 v[110:111], v14
    ds_read_b32 v112, v13 offset:45056
    v_add_u32 v14, 98304, v12
    ds_read_b64 v[114:115], v14
    ds_read_b32 v116, v13 offset:49152
    s_waitcnt lgkmcnt(10)
    s_add_u32 s41, s39, 86016
    buffer_store_dwordx3 v[94:96], v7, s[20:23], s41 offen
    s_waitcnt lgkmcnt(8)
    s_add_u32 s41, s39, 98304
    buffer_store_dwordx3 v[98:100], v7, s[20:23], s41 offen
    s_waitcnt lgkmcnt(6)
    s_add_u32 s41, s39, 110592
    buffer_store_dwordx3 v[102:104], v7, s[20:23], s41 offen
    s_waitcnt lgkmcnt(4)
    s_add_u32 s41, s39, 122880
    buffer_store_dwordx3 v[106:108], v7, s[20:23], s41 offen
    s_waitcnt lgkmcnt(2)
    s_add_u32 s41, s39, 135168
    buffer_store_dwordx3 v[110:112], v7, s[20:23], s41 offen
    s_waitcnt lgkmcnt(0)
    s_add_u32 s41, s39, 147456
    buffer_store_dwordx3 v[114:116], v8, s[20:23], s41 offen
    s_waitcnt vmcnt(12)
    v_mul_hi_u32_u24 v12, s32, v24
    v_mul_hi_u32_u24 v13, s33, v28
    v_mad_i32_i24 v14, v12, s34, v24
    v_lshl_add_u32 v13, v13, 8, v12
    v_and_b32 v15, 15, v14
    v_lshlrev_b32 v24, 2, v13
    v_lshl_or_b32 v15, v28, 5, v15
    v_lshrrev_b32 v14, 4, v14
    ds_add_rtn_u32 v94, v24, v5 offset:0
    v_lshl_or_b32 v28, v14, 24, v15
    v_mul_hi_u32_u24 v12, s32, v25
    v_mul_hi_u32_u24 v13, s33, v29
    v_mad_i32_i24 v14, v12, s34, v25
    v_lshl_add_u32 v13, v13, 8, v12
    v_and_b32 v15, 15, v14
    v_lshlrev_b32 v25, 2, v13
    v_lshl_or_b32 v15, v29, 5, v15
    v_lshrrev_b32 v14, 4, v14
    ds_add_rtn_u32 v95, v25, v5 offset:0
    v_lshl_or_b32 v29, v14, 24, v15
    v_mul_hi_u32_u24 v12, s32, v26
    v_mul_hi_u32_u24 v13, s33, v30
    v_mad_i32_i24 v14, v12, s34, v26
    v_lshl_add_u32 v13, v13, 8, v12
    v_and_b32 v15, 15, v14
    v_lshlrev_b32 v26, 2, v13
    v_lshl_or_b32 v15, v30, 5, v15
    v_lshrrev_b32 v14, 4, v14
    ds_add_rtn_u32 v96, v26, v5 offset:0
    v_lshl_or_b32 v30, v14, 24, v15
    v_mul_hi_u32_u24 v12, s32, v27
    v_mul_hi_u32_u24 v13, s33, v31
    v_mad_i32_i24 v14, v12, s34, v27
    v_lshl_add_u32 v13, v13, 8, v12
    v_and_b32 v15, 15, v14
    v_lshlrev_b32 v27, 2, v13
    v_lshl_or_b32 v15, v31, 5, v15
    v_lshrrev_b32 v14, 4, v14
    ds_add_rtn_u32 v97, v27, v5 offset:0
    v_lshl_or_b32 v31, v14, 24, v15
    s_waitcnt vmcnt(10)
    s_waitcnt lgkmcnt(0)
    v_lshl_or_b32 v94, v24, 16, v94
    v_lshl_or_b32 v95, v25, 16, v95
    v_lshl_or_b32 v96, v26, 16, v96
    v_lshl_or_b32 v97, v27, 16, v97
    v_mul_hi_u32_u24 v12, s32, v34
    v_mul_hi_u32_u24 v13, s33, v38
    v_mad_i32_i24 v14, v12, s34, v34
    v_lshl_add_u32 v13, v13, 8, v12
    v_and_b32 v15, 15, v14
    v_lshlrev_b32 v34, 2, v13
    v_lshl_or_b32 v15, v38, 5, v15
    v_lshrrev_b32 v14, 4, v14
    ds_add_rtn_u32 v98, v34, v5 offset:0
    v_lshl_or_b32 v38, v14, 24, v15
    v_mul_hi_u32_u24 v12, s32, v35
    v_mul_hi_u32_u24 v13, s33, v39
    v_mad_i32_i24 v14, v12, s34, v35
    v_lshl_add_u32 v13, v13, 8, v12
    v_and_b32 v15, 15, v14
    v_lshlrev_b32 v35, 2, v13
    v_lshl_or_b32 v15, v39, 5, v15
    v_lshrrev_b32 v14, 4, v14
    ds_add_rtn_u32 v99, v35, v5 offset:0
    v_lshl_or_b32 v39, v14, 24, v15
    v_mul_hi_u32_u24 v12, s32, v36
    v_mul_hi_u32_u24 v13, s33, v40
    v_mad_i32_i24 v14, v12, s34, v36
    v_lshl_add_u32 v13, v13, 8, v12
    v_and_b32 v15, 15, v14
    v_lshlrev_b32 v36, 2, v13
    v_lshl_or_b32 v15, v40, 5, v15
    v_lshrrev_b32 v14, 4, v14
    ds_add_rtn_u32 v100, v36, v5 offset:0
    v_lshl_or_b32 v40, v14, 24, v15
    v_mul_hi_u32_u24 v12, s32, v37
    v_mul_hi_u32_u24 v13, s33, v41
    v_mad_i32_i24 v14, v12, s34, v37
    v_lshl_add_u32 v13, v13, 8, v12
    v_and_b32 v15, 15, v14
    v_lshlrev_b32 v37, 2, v13
    v_lshl_or_b32 v15, v41, 5, v15
    v_lshrrev_b32 v14, 4, v14
    ds_add_rtn_u32 v101, v37, v5 offset:0
    v_lshl_or_b32 v41, v14, 24, v15
    s_waitcnt vmcnt(8)
    s_waitcnt lgkmcnt(0)
    v_lshl_or_b32 v98, v34, 16, v98
    v_lshl_or_b32 v99, v35, 16, v99
    v_lshl_or_b32 v100, v36, 16, v100
    v_lshl_or_b32 v101, v37, 16, v101
    v_mul_hi_u32_u24 v12, s32, v44
    v_mul_hi_u32_u24 v13, s33, v48
    v_mad_i32_i24 v14, v12, s34, v44
    v_lshl_add_u32 v13, v13, 8, v12
    v_and_b32 v15, 15, v14
    v_lshlrev_b32 v44, 2, v13
    v_lshl_or_b32 v15, v48, 5, v15
    v_lshrrev_b32 v14, 4, v14
    ds_add_rtn_u32 v102, v44, v5 offset:0
    v_lshl_or_b32 v48, v14, 24, v15
    v_mul_hi_u32_u24 v12, s32, v45
    v_mul_hi_u32_u24 v13, s33, v49
    v_mad_i32_i24 v14, v12, s34, v45
    v_lshl_add_u32 v13, v13, 8, v12
    v_and_b32 v15, 15, v14
    v_lshlrev_b32 v45, 2, v13
    v_lshl_or_b32 v15, v49, 5, v15
    v_lshrrev_b32 v14, 4, v14
    ds_add_rtn_u32 v103, v45, v5 offset:0
    v_lshl_or_b32 v49, v14, 24, v15
    v_mul_hi_u32_u24 v12, s32, v46
    v_mul_hi_u32_u24 v13, s33, v50
    v_mad_i32_i24 v14, v12, s34, v46
    v_lshl_add_u32 v13, v13, 8, v12
    v_and_b32 v15, 15, v14
    v_lshlrev_b32 v46, 2, v13
    v_lshl_or_b32 v15, v50, 5, v15
    v_lshrrev_b32 v14, 4, v14
    ds_add_rtn_u32 v104, v46, v5 offset:0
    v_lshl_or_b32 v50, v14, 24, v15
    v_mul_hi_u32_u24 v12, s32, v47
    v_mul_hi_u32_u24 v13, s33, v51
    v_mad_i32_i24 v14, v12, s34, v47
    v_lshl_add_u32 v13, v13, 8, v12
    v_and_b32 v15, 15, v14
    v_lshlrev_b32 v47, 2, v13
    v_lshl_or_b32 v15, v51, 5, v15
    v_lshrrev_b32 v14, 4, v14
    ds_add_rtn_u32 v105, v47, v5 offset:0
    v_lshl_or_b32 v51, v14, 24, v15
    s_waitcnt vmcnt(6)
    s_waitcnt lgkmcnt(0)
    v_lshl_or_b32 v102, v44, 16, v102
    v_lshl_or_b32 v103, v45, 16, v103
    v_lshl_or_b32 v104, v46, 16, v104
    v_lshl_or_b32 v105, v47, 16, v105
    v_mul_hi_u32_u24 v12, s32, v54
    v_mul_hi_u32_u24 v13, s33, v58
    v_mad_i32_i24 v14, v12, s34, v54
    v_lshl_add_u32 v13, v13, 8, v12
    v_and_b32 v15, 15, v14
    v_lshlrev_b32 v54, 2, v13
    v_lshl_or_b32 v15, v58, 5, v15
    v_lshrrev_b32 v14, 4, v14
    ds_add_rtn_u32 v106, v54, v5 offset:0
    v_lshl_or_b32 v58, v14, 24, v15
    v_mul_hi_u32_u24 v12, s32, v55
    v_mul_hi_u32_u24 v13, s33, v59
    v_mad_i32_i24 v14, v12, s34, v55
    v_lshl_add_u32 v13, v13, 8, v12
    v_and_b32 v15, 15, v14
    v_lshlrev_b32 v55, 2, v13
    v_lshl_or_b32 v15, v59, 5, v15
    v_lshrrev_b32 v14, 4, v14
    ds_add_rtn_u32 v107, v55, v5 offset:0
    v_lshl_or_b32 v59, v14, 24, v15
    v_mul_hi_u32_u24 v12, s32, v56
    v_mul_hi_u32_u24 v13, s33, v60
    v_mad_i32_i24 v14, v12, s34, v56
    v_lshl_add_u32 v13, v13, 8, v12
    v_and_b32 v15, 15, v14
    v_lshlrev_b32 v56, 2, v13
    v_lshl_or_b32 v15, v60, 5, v15
    v_lshrrev_b32 v14, 4, v14
    ds_add_rtn_u32 v108, v56, v5 offset:0
    v_lshl_or_b32 v60, v14, 24, v15
    v_mul_hi_u32_u24 v12, s32, v57
    v_mul_hi_u32_u24 v13, s33, v61
    v_mad_i32_i24 v14, v12, s34, v57
    v_lshl_add_u32 v13, v13, 8, v12
    v_and_b32 v15, 15, v14
    v_lshlrev_b32 v57, 2, v13
    v_lshl_or_b32 v15, v61, 5, v15
    v_lshrrev_b32 v14, 4, v14
    ds_add_rtn_u32 v109, v57, v5 offset:0
    v_lshl_or_b32 v61, v14, 24, v15
    s_waitcnt vmcnt(4)
    s_waitcnt lgkmcnt(0)
    v_lshl_or_b32 v106, v54, 16, v106
    v_lshl_or_b32 v107, v55, 16, v107
    v_lshl_or_b32 v108, v56, 16, v108
    v_lshl_or_b32 v109, v57, 16, v109
    v_mul_hi_u32_u24 v12, s32, v64
    v_mul_hi_u32_u24 v13, s33, v68
    v_mad_i32_i24 v14, v12, s34, v64
    v_lshl_add_u32 v13, v13, 8, v12
    v_and_b32 v15, 15, v14
    v_lshlrev_b32 v64, 2, v13
    v_lshl_or_b32 v15, v68, 5, v15
    v_lshrrev_b32 v14, 4, v14
    ds_add_rtn_u32 v110, v64, v5 offset:0
    v_lshl_or_b32 v68, v14, 24, v15
    v_mul_hi_u32_u24 v12, s32, v65
    v_mul_hi_u32_u24 v13, s33, v69
    v_mad_i32_i24 v14, v12, s34, v65
    v_lshl_add_u32 v13, v13, 8, v12
    v_and_b32 v15, 15, v14
    v_lshlrev_b32 v65, 2, v13
    v_lshl_or_b32 v15, v69, 5, v15
    v_lshrrev_b32 v14, 4, v14
    ds_add_rtn_u32 v111, v65, v5 offset:0
    v_lshl_or_b32 v69, v14, 24, v15
    v_mul_hi_u32_u24 v12, s32, v66
    v_mul_hi_u32_u24 v13, s33, v70
    v_mad_i32_i24 v14, v12, s34, v66
    v_lshl_add_u32 v13, v13, 8, v12
    v_and_b32 v15, 15, v14
    v_lshlrev_b32 v66, 2, v13
    v_lshl_or_b32 v15, v70, 5, v15
    v_lshrrev_b32 v14, 4, v14
    ds_add_rtn_u32 v112, v66, v5 offset:0
    v_lshl_or_b32 v70, v14, 24, v15
    v_mul_hi_u32_u24 v12, s32, v67
    v_mul_hi_u32_u24 v13, s33, v71
    v_mad_i32_i24 v14, v12, s34, v67
    v_lshl_add_u32 v13, v13, 8, v12
    v_and_b32 v15, 15, v14
    v_lshlrev_b32 v67, 2, v13
    v_lshl_or_b32 v15, v71, 5, v15
    v_lshrrev_b32 v14, 4, v14
    ds_add_rtn_u32 v113, v67, v5 offset:0
    v_lshl_or_b32 v71, v14, 24, v15
    s_waitcnt vmcnt(2)
    s_waitcnt lgkmcnt(0)
    v_lshl_or_b32 v110, v64, 16, v110
    v_lshl_or_b32 v111, v65, 16, v111
    v_lshl_or_b32 v112, v66, 16, v112
    v_lshl_or_b32 v113, v67, 16, v113
    v_mul_hi_u32_u24 v12, s32, v74
    v_mul_hi_u32_u24 v13, s33, v78
    v_mad_i32_i24 v14, v12, s34, v74
    v_lshl_add_u32 v13, v13, 8, v12
    v_and_b32 v15, 15, v14
    v_lshlrev_b32 v74, 2, v13
    v_lshl_or_b32 v15, v78, 5, v15
    v_lshrrev_b32 v14, 4, v14
    ds_add_rtn_u32 v114, v74, v5 offset:0
    v_lshl_or_b32 v78, v14, 24, v15
    v_mul_hi_u32_u24 v12, s32, v75
    v_mul_hi_u32_u24 v13, s33, v79
    v_mad_i32_i24 v14, v12, s34, v75
    v_lshl_add_u32 v13, v13, 8, v12
    v_and_b32 v15, 15, v14
    v_lshlrev_b32 v75, 2, v13
    v_lshl_or_b32 v15, v79, 5, v15
    v_lshrrev_b32 v14, 4, v14
    ds_add_rtn_u32 v115, v75, v5 offset:0
    v_lshl_or_b32 v79, v14, 24, v15
    v_mul_hi_u32_u24 v12, s32, v76
    v_mul_hi_u32_u24 v13, s33, v80
    v_mad_i32_i24 v14, v12, s34, v76
    v_lshl_add_u32 v13, v13, 8, v12
    v_and_b32 v15, 15, v14
    v_lshlrev_b32 v76, 2, v13
    v_lshl_or_b32 v15, v80, 5, v15
    v_lshrrev_b32 v14, 4, v14
    ds_add_rtn_u32 v116, v76, v5 offset:0
    v_lshl_or_b32 v80, v14, 24, v15
    v_mul_hi_u32_u24 v12, s32, v77
    v_mul_hi_u32_u24 v13, s33, v81
    v_mad_i32_i24 v14, v12, s34, v77
    v_lshl_add_u32 v13, v13, 8, v12
    v_and_b32 v15, 15, v14
    v_lshlrev_b32 v77, 2, v13
    v_lshl_or_b32 v15, v81, 5, v15
    v_lshrrev_b32 v14, 4, v14
    ds_add_rtn_u32 v117, v77, v5 offset:0
    v_lshl_or_b32 v81, v14, 24, v15
    s_waitcnt vmcnt(0)
    s_waitcnt lgkmcnt(0)
    v_lshl_or_b32 v114, v74, 16, v114
    v_lshl_or_b32 v115, v75, 16, v115
    v_lshl_or_b32 v116, v76, 16, v116
    v_lshl_or_b32 v117, v77, 16, v117
    v_cmp_gt_u32 vcc, 106, v0
    s_and_saveexec_b64 s[44:45], vcc
    s_cbranch_execz P1_SKIPQ_6
    v_mul_hi_u32_u24 v12, s32, v84
    v_mul_hi_u32_u24 v13, s33, v88
    v_mad_i32_i24 v14, v12, s34, v84
    v_lshl_add_u32 v13, v13, 8, v12
    v_and_b32 v15, 15, v14
    v_lshlrev_b32 v84, 2, v13
    v_lshl_or_b32 v15, v88, 5, v15
    v_lshrrev_b32 v14, 4, v14
    ds_add_rtn_u32 v118, v84, v5 offset:0
    v_lshl_or_b32 v88, v14, 24, v15
    v_mul_hi_u32_u24 v12, s32, v85
    v_mul_hi_u32_u24 v13, s33, v89
    v_mad_i32_i24 v14, v12, s34, v85
    v_lshl_add_u32 v13, v13, 8, v12
    v_and_b32 v15, 15, v14
    v_lshlrev_b32 v85, 2, v13
    v_lshl_or_b32 v15, v89, 5, v15
    v_lshrrev_b32 v14, 4, v14
    ds_add_rtn_u32 v119, v85, v5 offset:0
    v_lshl_or_b32 v89, v14, 24, v15
    v_mul_hi_u32_u24 v12, s32, v86
    v_mul_hi_u32_u24 v13, s33, v90
    v_mad_i32_i24 v14, v12, s34, v86
    v_lshl_add_u32 v13, v13, 8, v12
    v_and_b32 v15, 15, v14
    v_lshlrev_b32 v86, 2, v13
    v_lshl_or_b32 v15, v90, 5, v15
    v_lshrrev_b32 v14, 4, v14
    ds_add_rtn_u32 v120, v86, v5 offset:0
    v_lshl_or_b32 v90, v14, 24, v15
    v_mul_hi_u32_u24 v12, s32, v87
    v_mul_hi_u32_u24 v13, s33, v91
    v_mad_i32_i24 v14, v12, s34, v87
    v_lshl_add_u32 v13, v13, 8, v12
    v_and_b32 v15, 15, v14
    v_lshlrev_b32 v87, 2, v13
    v_lshl_or_b32 v15, v91, 5, v15
    v_lshrrev_b32 v14, 4, v14
    ds_add_rtn_u32 v121, v87, v5 offset:0
    v_lshl_or_b32 v91, v14, 24, v15
P1_SKIPQ_6:
    s_mov_b64 exec, s[44:45]
    s_waitcnt lgkmcnt(0)
    v_lshl_or_b32 v118, v84, 16, v118
    v_lshl_or_b32 v119, v85, 16, v119
    v_lshl_or_b32 v120, v86, 16, v120
    v_lshl_or_b32 v121, v87, 16, v121
    s_barrier
    v_lshlrev_b32 v18, 3, v0
    ds_read_b64 v[16:17], v18
    v_lshrrev_b32 v15, 4, v0
    v_and_b32 v15, 0xfc, v15
    s_waitcnt lgkmcnt(0)
    v_add_u32 v13, v16, v17
    v_mov_b32 v12, v13
    s_nop 1
    v_add_u32_dpp v12, v12, v12 row_shr:1 row_mask:0xf bank_mask:0xf
    s_nop 1
    v_add_u32_dpp v12, v12, v12 row_shr:2 row_mask:0xf bank_mask:0xf
    s_nop 1
    v_add_u32_dpp v12, v12, v12 row_shr:4 row_mask:0xf bank_mask:0xf
    s_nop 1
    v_add_u32_dpp v12, v12, v12 row_shr:8 row_mask:0xf bank_mask:0xf
    s_nop 1
    v_add_u32_dpp v12, v12, v12 row_bcast:15 row_mask:0xa bank_mask:0xf
    s_nop 1
    v_add_u32_dpp v12, v12, v12 row_bcast:31 row_mask:0xc bank_mask:0xf
    s_mov_b32 exec_lo, 0
    s_brev_b32 exec_hi, 1
    ds_write_b32 v15, v12 offset:8192
    s_mov_b64 exec, -1
    s_waitcnt lgkmcnt(0)
    s_barrier
    v_and_b32 v14, 15, v0
    v_lshlrev_b32 v14, 2, v14
    ds_read_b32 v14, v14 offset:8192
    s_waitcnt lgkmcnt(0)
    v_mov_b32 v15, v14
    s_nop 1
    v_add_u32_dpp v15, v15, v15 row_shr:1 row_mask:0xf bank_mask:0xf
    s_nop 1
    v_add_u32_dpp v15, v15, v15 row_shr:2 row_mask:0xf bank_mask:0xf
    s_nop 1
    v_add_u32_dpp v15, v15, v15 row_shr:4 row_mask:0xf bank_mask:0xf
    s_nop 1
    v_add_u32_dpp v15, v15, v15 row_shr:8 row_mask:0xf bank_mask:0xf
    v_sub_u32 v15, v15, v14
    s_nop 0
    v_readlane_b32 s43, v15, s40
    v_sub_u32 v14, v12, v13
    s_nop 1
    v_add_u32 v14, s43, v14
    v_add_u32 v12, s43, v12
    s_lshl_b32 s41, s36, 1
    v_add_u32 v17, v14, v16
    v_mov_b32 v16, v14
    ds_write_b64 v18, v[16:17]
    s_lshl_b32 s53, s2, 2
    v_lshl_or_b32 v122, v16, 16, v122
    v_lshl_or_b32 v123, v17, 16, v123
    v_lshl_or_b32 v124, v12, 16, v124
    s_waitcnt lgkmcnt(0)
    s_barrier
    v_lshrrev_b32 v12, 16, v94
    v_lshrrev_b32 v13, 16, v95
    v_lshrrev_b32 v14, 16, v96
    v_lshrrev_b32 v15, 16, v97
    ds_read_b32 v12, v12 offset:0
    ds_read_b32 v13, v13 offset:0
    ds_read_b32 v14, v14 offset:0
    ds_read_b32 v15, v15 offset:0
    v_lshrrev_b32 v16, 16, v98
    v_lshrrev_b32 v17, 16, v99
    v_lshrrev_b32 v18, 16, v100
    v_lshrrev_b32 v19, 16, v101
    ds_read_b32 v16, v16 offset:0
    ds_read_b32 v17, v17 offset:0
    ds_read_b32 v18, v18 offset:0
    ds_read_b32 v19, v19 offset:0
    s_waitcnt lgkmcnt(4)
    v_add_u32_sdwa v12, v12, v94 dst_sel:DWORD dst_unused:UNUSED_PAD src0_sel:DWORD src1_sel:WORD_0
    v_lshlrev_b32 v20, 2, v12
    v_lshl_add_u32 v21, v12, 1, s35
    ds_write_b32 v20, v28 offset:8448
    ds_write_b16 v21, v32
    v_add_u32_sdwa v13, v13, v95 dst_sel:DWORD dst_unused:UNUSED_PAD src0_sel:DWORD src1_sel:WORD_0
    v_lshlrev_b32 v20, 2, v13
    v_lshl_add_u32 v21, v13, 1, s35
    ds_write_b32 v20, v29 offset:8448
    ds_write_b16_d16_hi v21, v32
    v_add_u32_sdwa v14, v14, v96 dst_sel:DWORD dst_unused:UNUSED_PAD src0_sel:DWORD src1_sel:WORD_0
    v_lshlrev_b32 v20, 2, v14
    v_lshl_add_u32 v21, v14, 1, s35
    ds_write_b32 v20, v30 offset:8448
    ds_write_b16 v21, v33
    v_add_u32_sdwa v15, v15, v97 dst_sel:DWORD dst_unused:UNUSED_PAD src0_sel:DWORD src1_sel:WORD_0
    v_lshlrev_b32 v20, 2, v15
    v_lshl_add_u32 v21, v15, 1, s35
    ds_write_b32 v20, v31 offset:8448
    ds_write_b16_d16_hi v21, v33
    buffer_store_dword v122, v9, s[24:27], s53 offen
    v_lshrrev_b32 v12, 16, v102
    v_lshrrev_b32 v13, 16, v103
    v_lshrrev_b32 v14, 16, v104
    v_lshrrev_b32 v15, 16, v105
    ds_read_b32 v12, v12 offset:0
    ds_read_b32 v13, v13 offset:0
    ds_read_b32 v14, v14 offset:0
    ds_read_b32 v15, v15 offset:0
    s_waitcnt lgkmcnt(4)
    v_add_u32_sdwa v16, v16, v98 dst_sel:DWORD dst_unused:UNUSED_PAD src0_sel:DWORD src1_sel:WORD_0
    v_lshlrev_b32 v20, 2, v16
    v_lshl_add_u32 v21, v16, 1, s35
    ds_write_b32 v20, v38 offset:8448
    ds_write_b16 v21, v42
    v_add_u32_sdwa v17, v17, v99 dst_sel:DWORD dst_unused:UNUSED_PAD src0_sel:DWORD src1_sel:WORD_0
    v_lshlrev_b32 v20, 2, v17
    v_lshl_add_u32 v21, v17, 1, s35
    ds_write_b32 v20, v39 offset:8448
    ds_write_b16_d16_hi v21, v42
    v_add_u32_sdwa v18, v18, v100 dst_sel:DWORD dst_unused:UNUSED_PAD src0_sel:DWORD src1_sel:WORD_0
    v_lshlrev_b32 v20, 2, v18
    v_lshl_add_u32 v21, v18, 1, s35
    ds_write_b32 v20, v40 offset:8448
    ds_write_b16 v21, v43
    v_add_u32_sdwa v19, v19, v101 dst_sel:DWORD dst_unused:UNUSED_PAD src0_sel:DWORD src1_sel:WORD_0
    v_lshlrev_b32 v20, 2, v19
    v_lshl_add_u32 v21, v19, 1, s35
    ds_write_b32 v20, v41 offset:8448
    ds_write_b16_d16_hi v21, v43
    v_lshrrev_b32 v16, 16, v106
    v_lshrrev_b32 v17, 16, v107
    v_lshrrev_b32 v18, 16, v108
    v_lshrrev_b32 v19, 16, v109
    ds_read_b32 v16, v16 offset:0
    ds_read_b32 v17, v17 offset:0
    ds_read_b32 v18, v18 offset:0
    ds_read_b32 v19, v19 offset:0
    s_waitcnt lgkmcnt(4)
    v_add_u32_sdwa v12, v12, v102 dst_sel:DWORD dst_unused:UNUSED_PAD src0_sel:DWORD src1_sel:WORD_0
    v_lshlrev_b32 v20, 2, v12
    v_lshl_add_u32 v21, v12, 1, s35
    ds_write_b32 v20, v48 offset:8448
    ds_write_b16 v21, v52
    v_add_u32_sdwa v13, v13, v103 dst_sel:DWORD dst_unused:UNUSED_PAD src0_sel:DWORD src1_sel:WORD_0
    v_lshlrev_b32 v20, 2, v13
    v_lshl_add_u32 v21, v13, 1, s35
    ds_write_b32 v20, v49 offset:8448
    ds_write_b16_d16_hi v21, v52
    v_add_u32_sdwa v14, v14, v104 dst_sel:DWORD dst_unused:UNUSED_PAD src0_sel:DWORD src1_sel:WORD_0
    v_lshlrev_b32 v20, 2, v14
    v_lshl_add_u32 v21, v14, 1, s35
    ds_write_b32 v20, v50 offset:8448
    ds_write_b16 v21, v53
    v_add_u32_sdwa v15, v15, v105 dst_sel:DWORD dst_unused:UNUSED_PAD src0_sel:DWORD src1_sel:WORD_0
    v_lshlrev_b32 v20, 2, v15
    v_lshl_add_u32 v21, v15, 1, s35
    ds_write_b32 v20, v51 offset:8448
    ds_write_b16_d16_hi v21, v53
    v_lshrrev_b32 v12, 16, v110
    v_lshrrev_b32 v13, 16, v111
    v_lshrrev_b32 v14, 16, v112
    v_lshrrev_b32 v15, 16, v113
    ds_read_b32 v12, v12 offset:0
    ds_read_b32 v13, v13 offset:0
    ds_read_b32 v14, v14 offset:0
    ds_read_b32 v15, v15 offset:0
    s_waitcnt lgkmcnt(4)
    v_add_u32_sdwa v16, v16, v106 dst_sel:DWORD dst_unused:UNUSED_PAD src0_sel:DWORD src1_sel:WORD_0
    v_lshlrev_b32 v20, 2, v16
    v_lshl_add_u32 v21, v16, 1, s35
    ds_write_b32 v20, v58 offset:8448
    ds_write_b16 v21, v62
    v_add_u32_sdwa v17, v17, v107 dst_sel:DWORD dst_unused:UNUSED_PAD src0_sel:DWORD src1_sel:WORD_0
    v_lshlrev_b32 v20, 2, v17
    v_lshl_add_u32 v21, v17, 1, s35
    ds_write_b32 v20, v59 offset:8448
    ds_write_b16_d16_hi v21, v62
    v_add_u32_sdwa v18, v18, v108 dst_sel:DWORD dst_unused:UNUSED_PAD src0_sel:DWORD src1_sel:WORD_0
    v_lshlrev_b32 v20, 2, v18
    v_lshl_add_u32 v21, v18, 1, s35
    ds_write_b32 v20, v60 offset:8448
    ds_write_b16 v21, v63
    v_add_u32_sdwa v19, v19, v109 dst_sel:DWORD dst_unused:UNUSED_PAD src0_sel:DWORD src1_sel:WORD_0
    v_lshlrev_b32 v20, 2, v19
    v_lshl_add_u32 v21, v19, 1, s35
    ds_write_b32 v20, v61 offset:8448
    ds_write_b16_d16_hi v21, v63
    buffer_store_dword v123, v9, s[24:27], s53 offen offset:1024
    v_lshrrev_b32 v16, 16, v114
    v_lshrrev_b32 v17, 16, v115
    v_lshrrev_b32 v18, 16, v116
    v_lshrrev_b32 v19, 16, v117
    ds_read_b32 v16, v16 offset:0
    ds_read_b32 v17, v17 offset:0
    ds_read_b32 v18, v18 offset:0
    ds_read_b32 v19, v19 offset:0
    s_waitcnt lgkmcnt(4)
    v_add_u32_sdwa v12, v12, v110 dst_sel:DWORD dst_unused:UNUSED_PAD src0_sel:DWORD src1_sel:WORD_0
    v_lshlrev_b32 v20, 2, v12
    v_lshl_add_u32 v21, v12, 1, s35
    ds_write_b32 v20, v68 offset:8448
    ds_write_b16 v21, v72
    v_add_u32_sdwa v13, v13, v111 dst_sel:DWORD dst_unused:UNUSED_PAD src0_sel:DWORD src1_sel:WORD_0
    v_lshlrev_b32 v20, 2, v13
    v_lshl_add_u32 v21, v13, 1, s35
    ds_write_b32 v20, v69 offset:8448
    ds_write_b16_d16_hi v21, v72
    v_add_u32_sdwa v14, v14, v112 dst_sel:DWORD dst_unused:UNUSED_PAD src0_sel:DWORD src1_sel:WORD_0
    v_lshlrev_b32 v20, 2, v14
    v_lshl_add_u32 v21, v14, 1, s35
    ds_write_b32 v20, v70 offset:8448
    ds_write_b16 v21, v73
    v_add_u32_sdwa v15, v15, v113 dst_sel:DWORD dst_unused:UNUSED_PAD src0_sel:DWORD src1_sel:WORD_0
    v_lshlrev_b32 v20, 2, v15
    v_lshl_add_u32 v21, v15, 1, s35
    ds_write_b32 v20, v71 offset:8448
    ds_write_b16_d16_hi v21, v73
    v_cmp_gt_u32 vcc, 106, v0
    s_and_saveexec_b64 s[44:45], vcc
    s_cbranch_execz P1_SKIPQ_7
    v_lshrrev_b32 v12, 16, v118
    v_lshrrev_b32 v13, 16, v119
    v_lshrrev_b32 v14, 16, v120
    v_lshrrev_b32 v15, 16, v121
    ds_read_b32 v12, v12 offset:0
    ds_read_b32 v13, v13 offset:0
    ds_read_b32 v14, v14 offset:0
    ds_read_b32 v15, v15 offset:0
P1_SKIPQ_7:
    s_mov_b64 exec, s[44:45]
    s_waitcnt lgkmcnt(0)
    v_add_u32_sdwa v16, v16, v114 dst_sel:DWORD dst_unused:UNUSED_PAD src0_sel:DWORD src1_sel:WORD_0
    v_lshlrev_b32 v20, 2, v16
    v_lshl_add_u32 v21, v16, 1, s35
    ds_write_b32 v20, v78 offset:8448
    ds_write_b16 v21, v82
    v_add_u32_sdwa v17, v17, v115 dst_sel:DWORD dst_unused:UNUSED_PAD src0_sel:DWORD src1_sel:WORD_0
    v_lshlrev_b32 v20, 2, v17
    v_lshl_add_u32 v21, v17, 1, s35
    ds_write_b32 v20, v79 offset:8448
    ds_write_b16_d16_hi v21, v82
    v_add_u32_sdwa v18, v18, v116 dst_sel:DWORD dst_unused:UNUSED_PAD src0_sel:DWORD src1_sel:WORD_0
    v_lshlrev_b32 v20, 2, v18
    v_lshl_add_u32 v21, v18, 1, s35
    ds_write_b32 v20, v80 offset:8448
    ds_write_b16 v21, v83
    v_add_u32_sdwa v19, v19, v117 dst_sel:DWORD dst_unused:UNUSED_PAD src0_sel:DWORD src1_sel:WORD_0
    v_lshlrev_b32 v20, 2, v19
    v_lshl_add_u32 v21, v19, 1, s35
    ds_write_b32 v20, v81 offset:8448
    ds_write_b16_d16_hi v21, v83
    buffer_store_dword v124, v10, s[24:27], s53 offen
    s_waitcnt lgkmcnt(0)
    v_cmp_gt_u32 vcc, 106, v0
    s_and_saveexec_b64 s[44:45], vcc
    s_cbranch_execz P1_SKIPQ_8
    v_add_u32_sdwa v12, v12, v118 dst_sel:DWORD dst_unused:UNUSED_PAD src0_sel:DWORD src1_sel:WORD_0
    v_lshlrev_b32 v20, 2, v12
    v_lshl_add_u32 v21, v12, 1, s35
    ds_write_b32 v20, v88 offset:8448
    ds_write_b16 v21, v92
    v_add_u32_sdwa v13, v13, v119 dst_sel:DWORD dst_unused:UNUSED_PAD src0_sel:DWORD src1_sel:WORD_0
    v_lshlrev_b32 v20, 2, v13
    v_lshl_add_u32 v21, v13, 1, s35
    ds_write_b32 v20, v89 offset:8448
    ds_write_b16_d16_hi v21, v92
    v_add_u32_sdwa v14, v14, v120 dst_sel:DWORD dst_unused:UNUSED_PAD src0_sel:DWORD src1_sel:WORD_0
    v_lshlrev_b32 v20, 2, v14
    v_lshl_add_u32 v21, v14, 1, s35
    ds_write_b32 v20, v90 offset:8448
    ds_write_b16 v21, v93
    v_add_u32_sdwa v15, v15, v121 dst_sel:DWORD dst_unused:UNUSED_PAD src0_sel:DWORD src1_sel:WORD_0
    v_lshlrev_b32 v20, 2, v15
    v_lshl_add_u32 v21, v15, 1, s35
    ds_write_b32 v20, v91 offset:8448
    ds_write_b16_d16_hi v21, v93
P1_SKIPQ_8:
    s_mov_b64 exec, s[44:45]
    s_waitcnt lgkmcnt(0)
    s_barrier
    s_add_u32 s39, s39, 150000
    v_lshlrev_b32 v12, 3, v0
    v_add_u32 v12, 8448, v12
    v_add_u32 v13, s35, v6
    ds_read_b64 v[94:95], v12 offset:0
    ds_read_b32 v96, v13 offset:0
    ds_read_b64 v[98:99], v12 offset:8192
    ds_read_b32 v100, v13 offset:4096
    ds_read_b64 v[102:103], v12 offset:16384
    ds_read_b32 v104, v13 offset:8192
    ds_read_b64 v[106:107], v12 offset:24576
    ds_read_b32 v108, v13 offset:12288
    ds_read_b64 v[110:111], v12 offset:32768
    ds_read_b32 v112, v13 offset:16384
    ds_read_b64 v[114:115], v12 offset:40960
    ds_read_b32 v116, v13 offset:20480
    ds_read_b64 v[118:119], v12 offset:49152
    ds_read_b32 v120, v13 offset:24576
    s_waitcnt lgkmcnt(12)
    s_add_u32 s41, s39, 0
    buffer_store_dwordx3 v[94:96], v7, s[20:23], s41 offen
    s_waitcnt lgkmcnt(10)
    s_add_u32 s41, s39, 12288
    buffer_store_dwordx3 v[98:100], v7, s[20:23], s41 offen
    s_waitcnt lgkmcnt(8)
    s_add_u32 s41, s39, 24576
    buffer_store_dwordx3 v[102:104], v7, s[20:23], s41 offen
    s_waitcnt lgkmcnt(6)
    s_add_u32 s41, s39, 36864
    buffer_store_dwordx3 v[106:108], v7, s[20:23], s41 offen
    s_waitcnt lgkmcnt(4)
    s_add_u32 s41, s39, 49152
    buffer_store_dwordx3 v[110:112], v7, s[20:23], s41 offen
    s_waitcnt lgkmcnt(2)
    s_add_u32 s41, s39, 61440
    buffer_store_dwordx3 v[114:116], v7, s[20:23], s41 offen
    s_waitcnt lgkmcnt(0)
    s_add_u32 s41, s39, 73728
    buffer_store_dwordx3 v[118:120], v7, s[20:23], s41 offen
    s_nop 1
    ds_read_b64 v[94:95], v12 offset:57344
    ds_read_b32 v96, v13 offset:28672
    v_add_u32 v14, 65536, v12
    ds_read_b64 v[98:99], v14
    ds_read_b32 v100, v13 offset:32768
    v_add_u32 v14, 73728, v12
    ds_read_b64 v[102:103], v14
    ds_read_b32 v104, v13 offset:36864
    v_add_u32 v14, 81920, v12
    ds_read_b64 v[106:107], v14
    ds_read_b32 v108, v13 offset:40960
    v_add_u32 v14, 90112, v12
    ds_read_b64 v[110:111], v14
    ds_read_b32 v112, v13 offset:45056
    v_add_u32 v14, 98304, v12
    ds_read_b64 v[114:115], v14
    ds_read_b32 v116, v13 offset:49152
    s_waitcnt lgkmcnt(10)
    s_add_u32 s41, s39, 86016
    buffer_store_dwordx3 v[94:96], v7, s[20:23], s41 offen
    s_waitcnt lgkmcnt(8)
    s_add_u32 s41, s39, 98304
    buffer_store_dwordx3 v[98:100], v7, s[20:23], s41 offen
    s_waitcnt lgkmcnt(6)
    s_add_u32 s41, s39, 110592
    buffer_store_dwordx3 v[102:104], v7, s[20:23], s41 offen
    s_waitcnt lgkmcnt(4)
    s_add_u32 s41, s39, 122880
    buffer_store_dwordx3 v[106:108], v7, s[20:23], s41 offen
    s_waitcnt lgkmcnt(2)
    s_add_u32 s41, s39, 135168
    buffer_store_dwordx3 v[110:112], v7, s[20:23], s41 offen
    s_waitcnt lgkmcnt(0)
    s_add_u32 s41, s39, 147456
    buffer_store_dwordx3 v[114:116], v8, s[20:23], s41 offen
P1_END:
    s_endpgm
    .globl standalone__molecular_angular_gemnet__graph_kernel
    .p2align 8
    .type standalone__molecular_angular_gemnet__graph_kernel,@function
standalone__molecular_angular_gemnet__graph_kernel:
    s_cmp_ge_u32 s2, 256
    s_cbranch_scc1 P2_END
    s_load_dwordx2 s[4:5], s[0:1], 0
    s_load_dwordx2 s[6:7], s[0:1], 88
    s_load_dwordx2 s[80:81], s[0:1], 104
    s_and_b32 s64, s2, 7
    s_lshl_b32 s64, s64, 5
    s_lshr_b32 s65, s2, 3
    s_add_u32 s64, s64, s65
    s_mul_i32 s42, s64, 1563
    s_lshl_b32 s72, s64, 10
    v_lshrrev_b32 v36, 6, v0
    s_nop 0
    v_readfirstlane_b32 s3, v36
    s_waitcnt lgkmcnt(0)
    s_mov_b32 s8, s4
    s_and_b32 s9, s5, 0xffff
    s_mov_b32 s10, 12800000
    s_mov_b32 s11, 0x20000
    s_mov_b32 s20, s6
    s_and_b32 s21, s7, 0xffff
    s_mov_b32 s22, 12800000
    s_mov_b32 s23, 0x20000
    s_mov_b32 s12, s80
    s_and_b32 s13, s81, 0xffff
    s_mov_b32 s14, 76800000
    s_mov_b32 s15, 0x20000
    s_add_u32 s86, s80, 83886080
    s_addc_u32 s87, s81, 0
    s_mov_b32 s16, s86
    s_and_b32 s17, s87, 0xffff
    s_mov_b32 s18, 2098176
    s_mov_b32 s19, 0x20000
    s_lshr_b32 s53, s2, 3
    s_cmp_ge_u32 s3, 8
    s_cbranch_scc1 OFZ_10
    s_lshl_b32 s64, s3, 18
    s_add_u32 s64, s64, s72
    v_mbcnt_lo_u32_b32 v56, -1, 0
    v_mbcnt_hi_u32_b32 v56, -1, v56
    v_lshlrev_b32 v56, 4, v56
    buffer_load_dwordx4 v[48:51], v56, s[16:19], s64 offen
    buffer_load_dwordx4 v[52:55], v56, s[16:19], s64 offen offset:1024
    s_branch OFL_9
OFZ_10:
    v_mov_b32 v48, 0
    v_mov_b32 v49, 0
    v_mov_b32 v50, 0
    v_mov_b32 v51, 0
    v_mov_b32 v52, 0
    v_mov_b32 v53, 0
    v_mov_b32 v54, 0
    v_mov_b32 v55, 0
OFL_9:
    v_mov_b32 v44, 0
    v_mov_b32 v45, 0
    v_mov_b32 v46, 0
    v_mov_b32 v47, 0
    s_cmp_lt_u32 s3, 8
    s_cbranch_scc1 SKI_11
    v_subrev_u32 v25, 512, v0
    v_lshlrev_b32 v24, 2, v25
    v_mul_u32_u24 v26, 11, v25
    v_and_b32 v26, 15, v26
    v_lshlrev_b32 v26, 18, v26
    v_cmp_gt_u32 vcc, 98, v25
    s_and_saveexec_b64 s[68:69], vcc
    ds_write_b32 v24, v26 offset:25088
    s_mov_b64 exec, s[68:69]
    v_lshlrev_b32 v24, 4, v25
    v_add_u32 v24, 25728, v24
    v_and_b32 v32, 31, v25
    v_lshrrev_b32 v33, 5, v25
    v_mul_u32_u24 v33, 11, v33
    v_mov_b32 v34, 0x00ffffe0
    v_bfrev_b32 v35, 1
    v_add_u32 v26, 0, v33
    v_and_b32 v26, 15, v26
    v_cmp_lt_u32 vcc, v32, v26
    s_nop 1
    v_cndmask_b32 v28, v35, v34, vcc
    v_mov_b32 v29, v28
    v_mov_b32 v30, v28
    v_mov_b32 v31, v28
    v_add_u32 v26, 8, v33
    v_and_b32 v26, 15, v26
    v_cmp_lt_u32 vcc, v32, v26
    s_nop 1
    v_cndmask_b32 v40, v35, v34, vcc
    v_mov_b32 v41, v40
    v_mov_b32 v42, v40
    v_mov_b32 v43, v40
    ds_write_b128 v24, v[28:31] offset:0
    ds_write_b128 v24, v[40:43] offset:4096
    ds_write_b128 v24, v[28:31] offset:8192
    ds_write_b128 v24, v[40:43] offset:12288
    ds_write_b128 v24, v[28:31] offset:16384
    ds_write_b128 v24, v[40:43] offset:20480
    ds_write_b128 v24, v[28:31] offset:24576
    ds_write_b128 v24, v[40:43] offset:28672
    ds_write_b128 v24, v[28:31] offset:32768
    ds_write_b128 v24, v[40:43] offset:36864
    ds_write_b128 v24, v[28:31] offset:40960
    ds_write_b128 v24, v[40:43] offset:45056
    v_cmp_gt_u32 vcc, 64, v25
    s_and_saveexec_b64 s[68:69], vcc
    ds_write_b128 v24, v[28:31] offset:49152
    s_mov_b64 exec, s[68:69]
    v_lshrrev_b32 v33, 3, v25
    v_and_b32 v32, 7, v25
    v_lshlrev_b32 v33, 8, v33
    v_lshl_add_u32 v33, v32, 4, v33
    ds_write_b128 v33, v[44:47] offset:0
    ds_write_b128 v33, v[44:47] offset:8192
    ds_write_b128 v33, v[44:47] offset:16384
    v_cmp_gt_u32 vcc, 16, v25
    s_and_saveexec_b64 s[68:69], vcc
    ds_write_b128 v33, v[44:47] offset:24576
    s_mov_b64 exec, s[68:69]
    s_waitcnt lgkmcnt(0)
SKI_11:
    s_mov_b32 s38, 16777184
    s_mov_b32 s39, 0x06020100
    s_lshl_b32 s70, s3, 2
    s_mov_b32 s73, 0xffff
    s_mov_b32 s74, 128
    s_mul_i32 s71, s3, 4096
    s_add_u32 s71, s71, 94336
    s_mov_b32 s62, 255
    s_cmp_lt_u32 s3, 2
    s_cselect_b32 s62, 511, s62
    s_mov_b32 s63, 0
    s_mov_b32 s43, 0
    s_mov_b32 s46, 0
    v_and_b32 v36, 63, v0
    v_lshrrev_b32 v37, 4, v36
    v_bfe_u32 v38, v36, 2, 2
    v_and_b32 v39, 3, v36
    v_and_b32 v40, 7, v36
    v_lshlrev_b32 v8, 1, v40
    v_mul_u32_u24 v15, 12, v40
    v_lshrrev_b32 v40, 1, v36
    v_lshlrev_b32 v0, 2, v40
    v_lshlrev_b32 v1, 2, v36
    v_lshlrev_b32 v2, 1, v36
    v_and_b32 v41, 1, v36
    v_lshlrev_b32 v3, 4, v41
    s_mul_i32 s64, s3, 1536
    s_add_u32 s64, s64, 75904
    v_lshlrev_b32 v40, 3, v36
    v_add_u32 v7, s64, v40
    v_lshlrev_b32 v40, 3, v37
    v_lshl_add_u32 v40, v38, 1, v40
    v_lshlrev_b32 v41, 3, v40
    v_add_u32 v5, s64, v41
    v_lshlrev_b32 v41, 5, v40
    v_lshl_add_u32 v41, v39, 3, v41
    v_add_u32 v4, s71, v41
    v_lshlrev_b32 v6, 18, v39
    v_mul_u32_u24 v9, 48, v36
    v_add_u32 v9, s70, v9
    v_cmp_eq_u32 vcc, 15, v36
    v_mov_b32 v40, 508
    v_mov_b32 v17, 0
    v_cndmask_b32 v9, v9, v40, vcc
    v_cmp_eq_u32 vcc, 14, v36
    v_mov_b32 v40, 504
    s_nop 0
    v_cndmask_b32 v9, v9, v40, vcc
    v_lshrrev_b32 v40, 3, v36
    v_lshlrev_b32 v40, 2, v40
    v_add_u32 v21, 143488, v40
    s_branch P2_BUILD1
P2_BUILD:
    s_cmp_ge_u32 s3, 8
    s_cbranch_scc1 OFZ_13
    s_lshl_b32 s64, s3, 18
    s_add_u32 s64, s64, s72
    v_mbcnt_lo_u32_b32 v56, -1, 0
    v_mbcnt_hi_u32_b32 v56, -1, v56
    v_lshlrev_b32 v56, 4, v56
    buffer_load_dwordx4 v[48:51], v56, s[16:19], s64 offen
    buffer_load_dwordx4 v[52:55], v56, s[16:19], s64 offen offset:1024
    s_branch OFL_12
OFZ_13:
    v_mov_b32 v48, 0
    v_mov_b32 v49, 0
    v_mov_b32 v50, 0
    v_mov_b32 v51, 0
    v_mov_b32 v52, 0
    v_mov_b32 v53, 0
    v_mov_b32 v54, 0
    v_mov_b32 v55, 0
OFL_12:
P2_BUILD1:
    v_mbcnt_lo_u32_b32 v36, -1, 0
    v_mbcnt_hi_u32_b32 v36, -1, v36
    s_lshl_b32 s64, s3, 6
    v_add_u32 v36, s64, v36
    v_mov_b32 v24, 0
    v_mov_b32 v25, 0
    v_mov_b32 v26, 0
    v_mov_b32 v27, 0
    s_cmp_lt_u32 s3, 8
    s_cbranch_scc1 SKZ_14
    v_subrev_u32 v37, 512, v36
    v_lshlrev_b32 v38, 4, v37
    v_add_u32 v38, 143488, v38
    ds_write_b128 v38, v[24:27] offset:0
    ds_write_b128 v38, v[24:27] offset:4096
    ds_write_b128 v38, v[24:27] offset:8192
    ds_write_b128 v38, v[24:27] offset:12288
    v_cmp_gt_u32 vcc, 248, v37
    s_and_saveexec_b64 s[68:69], vcc
    ds_write_b128 v38, v[24:27] offset:16384
    s_mov_b64 exec, s[68:69]
SKZ_14:
    v_mov_b32 v24, 1572864
    v_cmp_eq_u32 vcc, 0, v36
    s_and_saveexec_b64 s[68:69], vcc
    v_mov_b32 v37, 25592
    ds_write_b64 v37, v[24:25]
    s_mov_b64 exec, s[68:69]
    v_and_b32 v34, 63, v36
    v_mul_u32_u24 v34, 200000, v34
    s_cmp_ge_u32 s3, 8
    s_cbranch_scc1 NOW_15
    s_waitcnt vmcnt(0)
NOW_15:
    v_mov_b32 v38, 0
    s_cmp_ge_u32 s3, 8
    s_cbranch_scc1 SKU_16
    v_sub_u16_sdwa v40, v52, v48 dst_sel:DWORD dst_unused:UNUSED_PAD src0_sel:WORD_0 src1_sel:WORD_0
    v_add_u32_sdwa v24, v34, v48 dst_sel:DWORD dst_unused:UNUSED_PAD src0_sel:DWORD src1_sel:WORD_0
    v_and_b32 v39, 1, v24
    v_add3_u32 v39, v39, v40, 15
    v_lshrrev_b32 v39, 4, v39
    v_cmp_lt_u32 vcc, 0, v40
    v_mov_b32 v32, 0
    s_nop 0
    v_cndmask_b32 v39, v32, v39, vcc
    v_add_u32 v38, v38, v39
    v_sub_u16_sdwa v41, v52, v48 dst_sel:DWORD dst_unused:UNUSED_PAD src0_sel:WORD_1 src1_sel:WORD_1
    v_add_u32_sdwa v25, v34, v48 dst_sel:DWORD dst_unused:UNUSED_PAD src0_sel:DWORD src1_sel:WORD_1
    v_add_u32 v25, 25000, v25
    v_and_b32 v39, 1, v25
    v_add3_u32 v39, v39, v41, 15
    v_lshrrev_b32 v39, 4, v39
    v_cmp_lt_u32 vcc, 0, v41
    v_mov_b32 v32, 0
    s_nop 0
    v_cndmask_b32 v39, v32, v39, vcc
    v_add_u32 v38, v38, v39
    v_sub_u16_sdwa v42, v53, v49 dst_sel:DWORD dst_unused:UNUSED_PAD src0_sel:WORD_0 src1_sel:WORD_0
    v_add_u32_sdwa v26, v34, v49 dst_sel:DWORD dst_unused:UNUSED_PAD src0_sel:DWORD src1_sel:WORD_0
    v_add_u32 v26, 50000, v26
    v_and_b32 v39, 1, v26
    v_add3_u32 v39, v39, v42, 15
    v_lshrrev_b32 v39, 4, v39
    v_cmp_lt_u32 vcc, 0, v42
    v_mov_b32 v32, 0
    s_nop 0
    v_cndmask_b32 v39, v32, v39, vcc
    v_add_u32 v38, v38, v39
    v_sub_u16_sdwa v43, v53, v49 dst_sel:DWORD dst_unused:UNUSED_PAD src0_sel:WORD_1 src1_sel:WORD_1
    v_add_u32_sdwa v27, v34, v49 dst_sel:DWORD dst_unused:UNUSED_PAD src0_sel:DWORD src1_sel:WORD_1
    v_add_u32 v27, 75000, v27
    v_and_b32 v39, 1, v27
    v_add3_u32 v39, v39, v43, 15
    v_lshrrev_b32 v39, 4, v39
    v_cmp_lt_u32 vcc, 0, v43
    v_mov_b32 v32, 0
    s_nop 0
    v_cndmask_b32 v39, v32, v39, vcc
    v_add_u32 v38, v38, v39
    v_sub_u16_sdwa v44, v54, v50 dst_sel:DWORD dst_unused:UNUSED_PAD src0_sel:WORD_0 src1_sel:WORD_0
    v_add_u32_sdwa v28, v34, v50 dst_sel:DWORD dst_unused:UNUSED_PAD src0_sel:DWORD src1_sel:WORD_0
    v_add_u32 v28, 100000, v28
    v_and_b32 v39, 1, v28
    v_add3_u32 v39, v39, v44, 15
    v_lshrrev_b32 v39, 4, v39
    v_cmp_lt_u32 vcc, 0, v44
    v_mov_b32 v32, 0
    s_nop 0
    v_cndmask_b32 v39, v32, v39, vcc
    v_add_u32 v38, v38, v39
    v_sub_u16_sdwa v45, v54, v50 dst_sel:DWORD dst_unused:UNUSED_PAD src0_sel:WORD_1 src1_sel:WORD_1
    v_add_u32_sdwa v29, v34, v50 dst_sel:DWORD dst_unused:UNUSED_PAD src0_sel:DWORD src1_sel:WORD_1
    v_add_u32 v29, 125000, v29
    v_and_b32 v39, 1, v29
    v_add3_u32 v39, v39, v45, 15
    v_lshrrev_b32 v39, 4, v39
    v_cmp_lt_u32 vcc, 0, v45
    v_mov_b32 v32, 0
    s_nop 0
    v_cndmask_b32 v39, v32, v39, vcc
    v_add_u32 v38, v38, v39
    v_sub_u16_sdwa v46, v55, v51 dst_sel:DWORD dst_unused:UNUSED_PAD src0_sel:WORD_0 src1_sel:WORD_0
    v_add_u32_sdwa v30, v34, v51 dst_sel:DWORD dst_unused:UNUSED_PAD src0_sel:DWORD src1_sel:WORD_0
    v_add_u32 v30, 150000, v30
    v_and_b32 v39, 1, v30
    v_add3_u32 v39, v39, v46, 15
    v_lshrrev_b32 v39, 4, v39
    v_cmp_lt_u32 vcc, 0, v46
    v_mov_b32 v32, 0
    s_nop 0
    v_cndmask_b32 v39, v32, v39, vcc
    v_add_u32 v38, v38, v39
    v_sub_u16_sdwa v47, v55, v51 dst_sel:DWORD dst_unused:UNUSED_PAD src0_sel:WORD_1 src1_sel:WORD_1
    v_add_u32_sdwa v31, v34, v51 dst_sel:DWORD dst_unused:UNUSED_PAD src0_sel:DWORD src1_sel:WORD_1
    v_add_u32 v31, 175000, v31
    v_and_b32 v39, 1, v31
    v_add3_u32 v39, v39, v47, 15
    v_lshrrev_b32 v39, 4, v39
    v_cmp_lt_u32 vcc, 0, v47
    v_mov_b32 v32, 0
    s_nop 0
    v_cndmask_b32 v39, v32, v39, vcc
    v_add_u32 v38, v38, v39
SKU_16:
    v_mov_b32 v39, v38
    s_nop 1
    v_add_u32_dpp v39, v39, v39 row_shr:1 row_mask:0xf bank_mask:0xf
    s_nop 1
    v_add_u32_dpp v39, v39, v39 row_shr:2 row_mask:0xf bank_mask:0xf
    s_nop 1
    v_add_u32_dpp v39, v39, v39 row_shr:4 row_mask:0xf bank_mask:0xf
    s_nop 1
    v_add_u32_dpp v39, v39, v39 row_shr:8 row_mask:0xf bank_mask:0xf
    s_nop 1
    v_add_u32_dpp v39, v39, v39 row_bcast:15 row_mask:0xa bank_mask:0xf
    s_nop 1
    v_add_u32_dpp v39, v39, v39 row_bcast:31 row_mask:0xc bank_mask:0xf
    v_mov_b32 v32, s70
    s_mov_b32 exec_lo, 0
    s_brev_b32 exec_hi, 1
    ds_write_b32 v32, v39 offset:25600
    s_mov_b64 exec, -1
    s_waitcnt lgkmcnt(0)
    s_barrier
    v_and_b32 v33, 15, v36
    v_cmp_gt_u32 vcc, 12, v33
    v_lshlrev_b32 v33, 2, v33
    ds_read_b32 v33, v33 offset:25600
    s_waitcnt lgkmcnt(0)
    v_mov_b32 v32, 0
    v_cndmask_b32 v33, v32, v33, vcc
    v_mov_b32 v32, v33
    s_nop 1
    v_add_u32_dpp v32, v32, v32 row_shr:1 row_mask:0xf bank_mask:0xf
    s_nop 1
    v_add_u32_dpp v32, v32, v32 row_shr:2 row_mask:0xf bank_mask:0xf
    s_nop 1
    v_add_u32_dpp v32, v32, v32 row_shr:4 row_mask:0xf bank_mask:0xf
    s_nop 1
    v_add_u32_dpp v32, v32, v32 row_shr:8 row_mask:0xf bank_mask:0xf
    s_nop 1
    v_readlane_b32 s47, v32, 15
    v_sub_u32 v32, v32, v33
    s_nop 0
    v_readlane_b32 s64, v32, s3
    v_sub_u32 v54, v39, v38
    s_nop 0
    v_add_u32 v54, s64, v54
    v_subrev_u32 v54, s46, v54
    s_mov_b32 s65, 5088
    s_cmp_ge_u32 s3, 8
    s_cbranch_scc1 SKB_17
    v_mov_b32 v48, 5088
    v_mov_b32 v49, 143488
    v_lshrrev_b32 v55, 1, v24
    v_and_b32 v56, 1, v24
    v_sub_u32 v57, 16, v56
    v_min_u32 v57, v57, v40
    v_lshl_or_b32 v58, v56, 23, v55
    v_lshl_or_b32 v58, v57, 24, v58
    v_sub_u32 v59, v40, v57
    v_cmp_lt_u32 vcc, 0, v40
    v_min_u32 v50, s65, v54
    v_min_u32 v51, 16, v59
    v_cndmask_b32 v50, v48, v50, vcc
    v_addc_co_u32 v54, vcc, 0, v54, vcc
    v_lshl_add_u32 v50, v50, 2, v49
    ds_write_b32 v50, v58
    v_add_u32 v52, 8, v55
    v_lshl_or_b32 v52, v51, 24, v52
    v_cmp_lt_u32 vcc, 0, v59
    v_min_u32 v56, s65, v54
    v_sub_u32 v53, v59, v51
    v_cndmask_b32 v56, v48, v56, vcc
    v_addc_co_u32 v54, vcc, 0, v54, vcc
    v_lshl_add_u32 v56, v56, 2, v49
    ds_write_b32 v56, v52
    v_cmp_lt_u32 vcc, 0, v53
    s_cbranch_vccnz LSLOW_18
LBACK_19:
    v_lshrrev_b32 v55, 1, v25
    v_and_b32 v56, 1, v25
    v_sub_u32 v57, 16, v56
    v_min_u32 v57, v57, v41
    v_lshl_or_b32 v58, v56, 23, v55
    v_lshl_or_b32 v58, v57, 24, v58
    v_sub_u32 v59, v41, v57
    v_cmp_lt_u32 vcc, 0, v41
    v_min_u32 v50, s65, v54
    v_min_u32 v51, 16, v59
    v_cndmask_b32 v50, v48, v50, vcc
    v_addc_co_u32 v54, vcc, 0, v54, vcc
    v_lshl_add_u32 v50, v50, 2, v49
    ds_write_b32 v50, v58
    v_add_u32 v52, 8, v55
    v_lshl_or_b32 v52, v51, 24, v52
    v_cmp_lt_u32 vcc, 0, v59
    v_min_u32 v56, s65, v54
    v_sub_u32 v53, v59, v51
    v_cndmask_b32 v56, v48, v56, vcc
    v_addc_co_u32 v54, vcc, 0, v54, vcc
    v_lshl_add_u32 v56, v56, 2, v49
    ds_write_b32 v56, v52
    v_cmp_lt_u32 vcc, 0, v53
    s_cbranch_vccnz LSLOW_21
LBACK_22:
    v_lshrrev_b32 v55, 1, v26
    v_and_b32 v56, 1, v26
    v_sub_u32 v57, 16, v56
    v_min_u32 v57, v57, v42
    v_lshl_or_b32 v58, v56, 23, v55
    v_lshl_or_b32 v58, v57, 24, v58
    v_sub_u32 v59, v42, v57
    v_cmp_lt_u32 vcc, 0, v42
    v_min_u32 v50, s65, v54
    v_min_u32 v51, 16, v59
    v_cndmask_b32 v50, v48, v50, vcc
    v_addc_co_u32 v54, vcc, 0, v54, vcc
    v_lshl_add_u32 v50, v50, 2, v49
    ds_write_b32 v50, v58
    v_add_u32 v52, 8, v55
    v_lshl_or_b32 v52, v51, 24, v52
    v_cmp_lt_u32 vcc, 0, v59
    v_min_u32 v56, s65, v54
    v_sub_u32 v53, v59, v51
    v_cndmask_b32 v56, v48, v56, vcc
    v_addc_co_u32 v54, vcc, 0, v54, vcc
    v_lshl_add_u32 v56, v56, 2, v49
    ds_write_b32 v56, v52
    v_cmp_lt_u32 vcc, 0, v53
    s_cbranch_vccnz LSLOW_24
LBACK_25:
    v_lshrrev_b32 v55, 1, v27
    v_and_b32 v56, 1, v27
    v_sub_u32 v57, 16, v56
    v_min_u32 v57, v57, v43
    v_lshl_or_b32 v58, v56, 23, v55
    v_lshl_or_b32 v58, v57, 24, v58
    v_sub_u32 v59, v43, v57
    v_cmp_lt_u32 vcc, 0, v43
    v_min_u32 v50, s65, v54
    v_min_u32 v51, 16, v59
    v_cndmask_b32 v50, v48, v50, vcc
    v_addc_co_u32 v54, vcc, 0, v54, vcc
    v_lshl_add_u32 v50, v50, 2, v49
    ds_write_b32 v50, v58
    v_add_u32 v52, 8, v55
    v_lshl_or_b32 v52, v51, 24, v52
    v_cmp_lt_u32 vcc, 0, v59
    v_min_u32 v56, s65, v54
    v_sub_u32 v53, v59, v51
    v_cndmask_b32 v56, v48, v56, vcc
    v_addc_co_u32 v54, vcc, 0, v54, vcc
    v_lshl_add_u32 v56, v56, 2, v49
    ds_write_b32 v56, v52
    v_cmp_lt_u32 vcc, 0, v53
    s_cbranch_vccnz LSLOW_27
LBACK_28:
    v_lshrrev_b32 v55, 1, v28
    v_and_b32 v56, 1, v28
    v_sub_u32 v57, 16, v56
    v_min_u32 v57, v57, v44
    v_lshl_or_b32 v58, v56, 23, v55
    v_lshl_or_b32 v58, v57, 24, v58
    v_sub_u32 v59, v44, v57
    v_cmp_lt_u32 vcc, 0, v44
    v_min_u32 v50, s65, v54
    v_min_u32 v51, 16, v59
    v_cndmask_b32 v50, v48, v50, vcc
    v_addc_co_u32 v54, vcc, 0, v54, vcc
    v_lshl_add_u32 v50, v50, 2, v49
    ds_write_b32 v50, v58
    v_add_u32 v52, 8, v55
    v_lshl_or_b32 v52, v51, 24, v52
    v_cmp_lt_u32 vcc, 0, v59
    v_min_u32 v56, s65, v54
    v_sub_u32 v53, v59, v51
    v_cndmask_b32 v56, v48, v56, vcc
    v_addc_co_u32 v54, vcc, 0, v54, vcc
    v_lshl_add_u32 v56, v56, 2, v49
    ds_write_b32 v56, v52
    v_cmp_lt_u32 vcc, 0, v53
    s_cbranch_vccnz LSLOW_30
LBACK_31:
    v_lshrrev_b32 v55, 1, v29
    v_and_b32 v56, 1, v29
    v_sub_u32 v57, 16, v56
    v_min_u32 v57, v57, v45
    v_lshl_or_b32 v58, v56, 23, v55
    v_lshl_or_b32 v58, v57, 24, v58
    v_sub_u32 v59, v45, v57
    v_cmp_lt_u32 vcc, 0, v45
    v_min_u32 v50, s65, v54
    v_min_u32 v51, 16, v59
    v_cndmask_b32 v50, v48, v50, vcc
    v_addc_co_u32 v54, vcc, 0, v54, vcc
    v_lshl_add_u32 v50, v50, 2, v49
    ds_write_b32 v50, v58
    v_add_u32 v52, 8, v55
    v_lshl_or_b32 v52, v51, 24, v52
    v_cmp_lt_u32 vcc, 0, v59
    v_min_u32 v56, s65, v54
    v_sub_u32 v53, v59, v51
    v_cndmask_b32 v56, v48, v56, vcc
    v_addc_co_u32 v54, vcc, 0, v54, vcc
    v_lshl_add_u32 v56, v56, 2, v49
    ds_write_b32 v56, v52
    v_cmp_lt_u32 vcc, 0, v53
    s_cbranch_vccnz LSLOW_33
LBACK_34:
    v_lshrrev_b32 v55, 1, v30
    v_and_b32 v56, 1, v30
    v_sub_u32 v57, 16, v56
    v_min_u32 v57, v57, v46
    v_lshl_or_b32 v58, v56, 23, v55
    v_lshl_or_b32 v58, v57, 24, v58
    v_sub_u32 v59, v46, v57
    v_cmp_lt_u32 vcc, 0, v46
    v_min_u32 v50, s65, v54
    v_min_u32 v51, 16, v59
    v_cndmask_b32 v50, v48, v50, vcc
    v_addc_co_u32 v54, vcc, 0, v54, vcc
    v_lshl_add_u32 v50, v50, 2, v49
    ds_write_b32 v50, v58
    v_add_u32 v52, 8, v55
    v_lshl_or_b32 v52, v51, 24, v52
    v_cmp_lt_u32 vcc, 0, v59
    v_min_u32 v56, s65, v54
    v_sub_u32 v53, v59, v51
    v_cndmask_b32 v56, v48, v56, vcc
    v_addc_co_u32 v54, vcc, 0, v54, vcc
    v_lshl_add_u32 v56, v56, 2, v49
    ds_write_b32 v56, v52
    v_cmp_lt_u32 vcc, 0, v53
    s_cbranch_vccnz LSLOW_36
LBACK_37:
    v_lshrrev_b32 v55, 1, v31
    v_and_b32 v56, 1, v31
    v_sub_u32 v57, 16, v56
    v_min_u32 v57, v57, v47
    v_lshl_or_b32 v58, v56, 23, v55
    v_lshl_or_b32 v58, v57, 24, v58
    v_sub_u32 v59, v47, v57
    v_cmp_lt_u32 vcc, 0, v47
    v_min_u32 v50, s65, v54
    v_min_u32 v51, 16, v59
    v_cndmask_b32 v50, v48, v50, vcc
    v_addc_co_u32 v54, vcc, 0, v54, vcc
    v_lshl_add_u32 v50, v50, 2, v49
    ds_write_b32 v50, v58
    v_add_u32 v52, 8, v55
    v_lshl_or_b32 v52, v51, 24, v52
    v_cmp_lt_u32 vcc, 0, v59
    v_min_u32 v56, s65, v54
    v_sub_u32 v53, v59, v51
    v_cndmask_b32 v56, v48, v56, vcc
    v_addc_co_u32 v54, vcc, 0, v54, vcc
    v_lshl_add_u32 v56, v56, 2, v49
    ds_write_b32 v56, v52
    v_cmp_lt_u32 vcc, 0, v53
    s_cbranch_vccnz LSLOW_39
LBACK_40:
SKB_17:
    s_sub_u32 s64, s47, s46
    s_min_u32 s64, s64, 5088
    s_add_u32 s64, s64, 7
    s_lshr_b32 s64, s64, 3
    s_lshl_b32 s41, s64, 5
    s_mov_b32 s60, 0
    s_mov_b32 s36, 0
    s_waitcnt lgkmcnt(0)
    s_barrier
    v_mov_b32 v52, 0x10000
    s_lshl_b32 s40, s3, 5
    v_add_u32 v53, s40, v21
    ds_read_b32 v58, v53
    ds_read_b32 v59, v53 offset:384
    s_mov_b64 exec, 0x4000
    ds_add_rtn_u32 v10, v9, v52 offset:25088
    s_mov_b64 exec, -1
    s_waitcnt lgkmcnt(1)
    v_bfe_u32 v56, v58, 23, 1
    v_and_b32 v57, 0x7fffff, v58
    v_sub_u32 v56, v8, v56
    v_mad_u32_u24 v57, v57, 12, v15
    v_cmp_lt_u32_sdwa s[28:29], v56, v58 src0_sel:DWORD src1_sel:BYTE_3
    v_add_u32 v56, 1, v56
    v_cmp_lt_u32_sdwa s[30:31], v56, v58 src0_sel:DWORD src1_sel:BYTE_3
    s_or_b64 s[64:65], s[28:29], s[30:31]
    v_cndmask_b32_e64 v57, -16, v57, s[64:65]
    buffer_load_dwordx3 v[12:14], v57, s[12:15], 0 offen
    s_mov_b64 exec, 1
    v_mov_b32 v11, -16
    buffer_load_dword v11, v11, s[12:15], 0 offen
    buffer_load_dword v11, v11, s[12:15], 0 offen
    s_mov_b64 exec, -1
    s_mov_b64 exec, 1
    v_mov_b32 v11, -16
    buffer_load_dword v11, v11, s[12:15], 0 offen
    buffer_load_dword v11, v11, s[12:15], 0 offen
    s_mov_b64 exec, -1
    v_bfe_u32 v56, v59, 23, 1
    v_and_b32 v57, 0x7fffff, v59
    v_sub_u32 v56, v8, v56
    v_mad_u32_u24 v57, v57, 12, v15
    v_cmp_lt_u32_sdwa s[32:33], v56, v59 src0_sel:DWORD src1_sel:BYTE_3
    v_add_u32 v56, 1, v56
    v_cmp_lt_u32_sdwa s[34:35], v56, v59 src0_sel:DWORD src1_sel:BYTE_3
    s_or_b64 s[64:65], s[32:33], s[34:35]
    v_cndmask_b32_e64 v57, -16, v57, s[64:65]
    buffer_load_dwordx3 v[18:20], v57, s[12:15], 0 offen
    s_mov_b64 exec, 1
    v_mov_b32 v11, -16
    buffer_load_dword v11, v11, s[12:15], 0 offen
    buffer_load_dword v11, v11, s[12:15], 0 offen
    s_mov_b64 exec, -1
    s_mov_b64 exec, 1
    v_mov_b32 v11, -16
    buffer_load_dword v11, v11, s[12:15], 0 offen
    buffer_load_dword v11, v11, s[12:15], 0 offen
    s_mov_b64 exec, -1
    s_waitcnt lgkmcnt(0)
    s_cmp_lg_u32 s46, 0
    s_cbranch_scc1 LZ_42
    v_mov_b32 v40, 0
    v_mov_b32 v41, 0
    v_mov_b32 v42, 0
    v_mov_b32 v43, 0
    s_nop 1
    v_mfma_f32_32x32x16_bf16 a[0:15], v[40:43], v[40:43], 0
    v_mfma_f32_32x32x16_bf16 a[16:31], v[40:43], v[40:43], 0
    v_mfma_f32_32x32x16_bf16 a[32:47], v[40:43], v[40:43], 0
    v_mfma_f32_32x32x16_bf16 a[48:63], v[40:43], v[40:43], 0
    v_mfma_f32_32x32x16_bf16 a[64:79], v[40:43], v[40:43], 0
    v_mfma_f32_32x32x16_bf16 a[80:95], v[40:43], v[40:43], 0
    v_mfma_f32_16x16x32_bf16 a[96:99], v[40:43], v[40:43], 0
    v_mfma_f32_16x16x32_bf16 a[100:103], v[40:43], v[40:43], 0
    v_mfma_f32_16x16x32_bf16 a[104:107], v[40:43], v[40:43], 0
    s_nop 7
    s_nop 7
    s_nop 3
LZ_42:
    s_mov_b32 s88, 0
    s_mov_b32 s89, 0
    s_mov_b32 s78, 0
    s_mov_b32 s79, 0
    s_setprio 1
P2_LOOP:
    s_add_u32 s88, s88, 1
    s_cmp_gt_u32 s88, 16777216
    s_cbranch_scc1 P2_FLUSH
    s_cmp_lg_u32 s60, 0
    s_cbranch_scc1 DRAIN_49
    s_waitcnt vmcnt(9)
    v_readlane_b32 s40, v10, 14
    s_lshr_b32 s40, s40, 11
    v_add_u32 v57, s40, v21
    ds_read_b32 v58, v57
    ds_read_b32 v59, v9 offset:25088
    v_lshlrev_b32_sdwa v54, 2, v12 dst_sel:DWORD dst_unused:UNUSED_PAD src0_sel:DWORD src1_sel:BYTE_3
    v_lshlrev_b32_sdwa v55, 2, v13 dst_sel:DWORD dst_unused:UNUSED_PAD src0_sel:DWORD src1_sel:BYTE_3
    v_mov_b32 v52, 0x10000
    s_cmp_lg_u32 s36, 0
    s_cbranch_scc1 RETRYRD_44
    s_mov_b64 exec, s[28:29]
    ds_add_rtn_u32 v22, v54, v52 offset:25088
    s_mov_b64 exec, s[30:31]
    ds_add_rtn_u32 v23, v55, v52 offset:25088
COMMON_45:
    s_waitcnt lgkmcnt(0)
    s_mov_b64 exec, s[28:29]
    v_sub_u16_sdwa v36, v22, v22 dst_sel:DWORD dst_unused:UNUSED_PAD src0_sel:WORD_1 src1_sel:WORD_0
    v_lshrrev_b32 v37, 14, v22
    v_cmpx_gt_u32 vcc, s74, v36
    v_and_b32 v37, 0x1fc, v37
    v_perm_b32 v38, v22, v12, s39
    v_mad_u32_u24 v37, v54, s74, v37
    s_andn2_b64 s[28:29], s[28:29], exec
    v_lshrrev_b32 v36, 1, v37
    ds_write_b16 v36, v14 offset:0
    ds_write_b32 v37, v38 offset:25728
    s_mov_b64 exec, s[30:31]
    v_sub_u16_sdwa v36, v23, v23 dst_sel:DWORD dst_unused:UNUSED_PAD src0_sel:WORD_1 src1_sel:WORD_0
    v_lshrrev_b32 v37, 14, v23
    v_cmpx_gt_u32 vcc, s74, v36
    v_and_b32 v37, 0x1fc, v37
    v_perm_b32 v38, v23, v13, s39
    v_mad_u32_u24 v37, v55, s74, v37
    s_andn2_b64 s[30:31], s[30:31], exec
    v_lshrrev_b32 v36, 1, v37
    ds_write_b16_d16_hi v36, v14 offset:0
    ds_write_b32 v37, v38 offset:25728
    s_mov_b64 exec, -1
    s_or_b64 s[64:65], s[28:29], s[30:31]
    s_cbranch_scc1 PEND_46
    s_mov_b32 s36, 0
    v_bfe_u32 v56, v58, 23, 1
    v_and_b32 v57, 0x7fffff, v58
    v_sub_u32 v56, v8, v56
    v_mad_u32_u24 v57, v57, 12, v15
    v_cmp_lt_u32_sdwa s[28:29], v56, v58 src0_sel:DWORD src1_sel:BYTE_3
    v_add_u32 v56, 1, v56
    v_cmp_lt_u32_sdwa s[30:31], v56, v58 src0_sel:DWORD src1_sel:BYTE_3
    s_or_b64 s[64:65], s[28:29], s[30:31]
    v_cndmask_b32_e64 v57, -16, v57, s[64:65]
    buffer_load_dwordx3 v[12:14], v57, s[12:15], 0 offen
    s_mov_b64 exec, 0x4000
    ds_add_rtn_u32 v10, v9, v52 offset:25088
    s_mov_b64 exec, -1
ISSUED_47:
    s_cmp_lt_u32 s40, s41
    s_cbranch_scc1 NODONE_48
    s_or_b64 s[64:65], s[28:29], s[30:31]
    s_or_b64 s[64:65], s[64:65], s[32:33]
    s_or_b64 s[64:65], s[64:65], s[34:35]
    s_cbranch_scc1 NODONE_48
    s_cmp_lg_u32 s36, 0
    s_cbranch_scc1 NODONE_48
    s_mov_b32 s60, 1
    s_mov_b32 s79, s88
    s_setprio 0
    s_mov_b64 exec, 1
    v_mov_b32 v36, 25596
    v_mov_b32 v37, 1
    ds_add_u32 v36, v37
    s_mov_b64 exec, -1
NODONE_48:
POLL_50:
    v_readlane_b32 s37, v59, 15
    v_mov_b32 v37, -1
    s_mov_b64 exec, s[62:63]
    v_sub_u16_sdwa v36, v59, v59 dst_sel:DWORD dst_unused:UNUSED_PAD src0_sel:WORD_1 src1_sel:WORD_0
    v_lshlrev_b32 v37, 7, v9
    v_and_b32 v38, 64, v59
    v_lshl_add_u32 v37, v38, 2, v37
    v_lshl_or_b32 v37, v59, 16, v37
    v_cmp_le_u32 vcc, 64, v36
    s_mov_b32 s58, vcc_lo
    v_cmp_le_u32 vcc, 0x60, v36
    s_andn2_b32 s58, s58, vcc_lo
    s_lshl_b32 s58, s58, 16
    s_or_b32 s58, s58, vcc_lo
    s_ff1_i32_b32 s59, s58
    s_bitset0_b32 s58, s59
    s_and_b32 s54, s59, 15
    v_readlane_b32 s50, v37, s54
    s_ff1_i32_b32 s59, s58
    s_bitset0_b32 s58, s59
    s_and_b32 s55, s59, 15
    v_readlane_b32 s51, v37, s55
    s_mov_b64 exec, -1
    s_cmp_eq_u32 s50, -1
    s_cbranch_scc1 NOPICK_51
    s_and_b32 s66, s50, 0xffff
    s_lshr_b32 s67, s66, 1
    v_add_u32 v25, s66, v0
    v_add_u32 v26, s66, v1
    v_add_u32 v27, s67, v2
    ds_read_b32 v24, v25 offset:25728
    ds_read_b32 v25, v25 offset:25856
    ds_read_b32 v26, v26 offset:25728
    ds_read_u16_d16_hi v27, v27 offset:0
NOPICK_51:
    s_bitcmp1_b32 s43, 0
    s_cbranch_scc0 NOOLD_52
    v_mul_f32 v40, 0.15915494, v31
    v_mul_f32 v42, 0x40400000, v31
    v_fract_f32 v40, v40
    v_cvt_pk_bf16_f32 v42, 0, v42
    v_cos_f32 v40, v40
    v_mul_f32 v42, 0.15915494, v42
    v_and_b32_sdwa v38, 12, v28 dst_sel:WORD_1 dst_unused:UNUSED_PAD src0_sel:DWORD src1_sel:BYTE_0
    v_fract_f32 v42, v42
    v_lshlrev_b32 v43, 4, v30
    v_xor_b32_dpp v52, v38, v6 quad_perm:[0,0,0,0] row_mask:0xf bank_mask:0xf
    v_xor_b32_dpp v53, v38, v6 quad_perm:[2,2,2,2] row_mask:0xf bank_mask:0xf
    v_and_b32_sdwa v38, 12, v29 dst_sel:WORD_1 dst_unused:UNUSED_PAD src0_sel:DWORD src1_sel:BYTE_0
    v_cos_f32 v42, v42
    v_add_f32 v41, v40, v40
    v_xor_b32_dpp v54, v38, v6 quad_perm:[0,0,0,0] row_mask:0xf bank_mask:0xf
    v_xor_b32_dpp v55, v38, v6 quad_perm:[2,2,2,2] row_mask:0xf bank_mask:0xf
    v_cvt_pk_bf16_f32 v16, v40, 0
    v_fma_f32 v41, v41, v40, -1.0
    v_lshlrev_b64 v[44:45], v43, v[16:17]
    v_cvt_pk_bf16_f32 v16, v41, 0
    ds_write_b64 v7, v[44:45]
    v_lshlrev_b64 v[46:47], v43, v[16:17]
    v_cvt_pk_bf16_f32 v16, v42, 0
    ds_write_b64 v7, v[46:47] offset:512
    v_lshlrev_b64 v[48:49], v43, v[16:17]
    v_add_u32 v52, v52, v5
    v_add_u32 v53, v53, v5
    v_add_u32 v54, v54, v5
    v_add_u32 v55, v55, v5
    ds_write_b64 v7, v[48:49] offset:1024
    s_waitcnt vmcnt(3)
    ds_read_b64_tr_b16 v[36:37], v4 offset:0
    ds_read_b64_tr_b16 v[38:39], v4 offset:32
    ds_read_b64_tr_b16 v[40:41], v52 offset:0
    ds_read_b64_tr_b16 v[42:43], v53 offset:8
    ds_read_b64_tr_b16 v[44:45], v52 offset:512
    ds_read_b64_tr_b16 v[46:47], v53 offset:520
    ds_read_b64_tr_b16 v[48:49], v52 offset:1024
    ds_read_b64_tr_b16 v[50:51], v53 offset:1032
    s_cmp_ge_u32 s44, 5
    s_cbranch_scc1 MT_59
    s_cmp_ge_u32 s44, 3
    s_cbranch_scc1 MT_60
    s_cmp_ge_u32 s44, 2
    s_cbranch_scc1 MT_61
    s_cmp_ge_u32 s44, 1
    s_cbranch_scc1 MT_62
    s_waitcnt lgkmcnt(0)
    v_mfma_f32_16x16x32_bf16 a[0:3], v[36:39], v[40:43], a[0:3]
    v_mfma_f32_16x16x32_bf16 a[4:7], v[36:39], v[44:47], a[4:7]
    v_mfma_f32_16x16x32_bf16 a[8:11], v[36:39], v[48:51], a[8:11]
    ds_read_b64_tr_b16 v[36:37], v4 offset:1024
    ds_read_b64_tr_b16 v[38:39], v4 offset:1056
    ds_read_b64_tr_b16 v[40:41], v54 offset:256
    ds_read_b64_tr_b16 v[42:43], v55 offset:264
    ds_read_b64_tr_b16 v[44:45], v54 offset:768
    ds_read_b64_tr_b16 v[46:47], v55 offset:776
    ds_read_b64_tr_b16 v[48:49], v54 offset:1280
    ds_read_b64_tr_b16 v[50:51], v55 offset:1288
    s_waitcnt lgkmcnt(0)
    v_mfma_f32_16x16x32_bf16 a[0:3], v[36:39], v[40:43], a[0:3]
    v_mfma_f32_16x16x32_bf16 a[4:7], v[36:39], v[44:47], a[4:7]
    v_mfma_f32_16x16x32_bf16 a[8:11], v[36:39], v[48:51], a[8:11]
    s_branch MDONE_58
MT_62:
    s_waitcnt lgkmcnt(0)
    v_mfma_f32_16x16x32_bf16 a[12:15], v[36:39], v[40:43], a[12:15]
    v_mfma_f32_16x16x32_bf16 a[16:19], v[36:39], v[44:47], a[16:19]
    v_mfma_f32_16x16x32_bf16 a[20:23], v[36:39], v[48:51], a[20:23]
    ds_read_b64_tr_b16 v[36:37], v4 offset:1024
    ds_read_b64_tr_b16 v[38:39], v4 offset:1056
    ds_read_b64_tr_b16 v[40:41], v54 offset:256
    ds_read_b64_tr_b16 v[42:43], v55 offset:264
    ds_read_b64_tr_b16 v[44:45], v54 offset:768
    ds_read_b64_tr_b16 v[46:47], v55 offset:776
    ds_read_b64_tr_b16 v[48:49], v54 offset:1280
    ds_read_b64_tr_b16 v[50:51], v55 offset:1288
    s_waitcnt lgkmcnt(0)
    v_mfma_f32_16x16x32_bf16 a[12:15], v[36:39], v[40:43], a[12:15]
    v_mfma_f32_16x16x32_bf16 a[16:19], v[36:39], v[44:47], a[16:19]
    v_mfma_f32_16x16x32_bf16 a[20:23], v[36:39], v[48:51], a[20:23]
    s_branch MDONE_58
MT_61:
    s_waitcnt lgkmcnt(0)
    v_mfma_f32_16x16x32_bf16 a[24:27], v[36:39], v[40:43], a[24:27]
    v_mfma_f32_16x16x32_bf16 a[28:31], v[36:39], v[44:47], a[28:31]
    v_mfma_f32_16x16x32_bf16 a[32:35], v[36:39], v[48:51], a[32:35]
    ds_read_b64_tr_b16 v[36:37], v4 offset:1024
    ds_read_b64_tr_b16 v[38:39], v4 offset:1056
    ds_read_b64_tr_b16 v[40:41], v54 offset:256
    ds_read_b64_tr_b16 v[42:43], v55 offset:264
    ds_read_b64_tr_b16 v[44:45], v54 offset:768
    ds_read_b64_tr_b16 v[46:47], v55 offset:776
    ds_read_b64_tr_b16 v[48:49], v54 offset:1280
    ds_read_b64_tr_b16 v[50:51], v55 offset:1288
    s_waitcnt lgkmcnt(0)
    v_mfma_f32_16x16x32_bf16 a[24:27], v[36:39], v[40:43], a[24:27]
    v_mfma_f32_16x16x32_bf16 a[28:31], v[36:39], v[44:47], a[28:31]
    v_mfma_f32_16x16x32_bf16 a[32:35], v[36:39], v[48:51], a[32:35]
    s_branch MDONE_58
MT_60:
    s_cmp_ge_u32 s44, 4
    s_cbranch_scc1 MT_63
    s_waitcnt lgkmcnt(0)
    v_mfma_f32_16x16x32_bf16 a[36:39], v[36:39], v[40:43], a[36:39]
    v_mfma_f32_16x16x32_bf16 a[40:43], v[36:39], v[44:47], a[40:43]
    v_mfma_f32_16x16x32_bf16 a[44:47], v[36:39], v[48:51], a[44:47]
    ds_read_b64_tr_b16 v[36:37], v4 offset:1024
    ds_read_b64_tr_b16 v[38:39], v4 offset:1056
    ds_read_b64_tr_b16 v[40:41], v54 offset:256
    ds_read_b64_tr_b16 v[42:43], v55 offset:264
    ds_read_b64_tr_b16 v[44:45], v54 offset:768
    ds_read_b64_tr_b16 v[46:47], v55 offset:776
    ds_read_b64_tr_b16 v[48:49], v54 offset:1280
    ds_read_b64_tr_b16 v[50:51], v55 offset:1288
    s_waitcnt lgkmcnt(0)
    v_mfma_f32_16x16x32_bf16 a[36:39], v[36:39], v[40:43], a[36:39]
    v_mfma_f32_16x16x32_bf16 a[40:43], v[36:39], v[44:47], a[40:43]
    v_mfma_f32_16x16x32_bf16 a[44:47], v[36:39], v[48:51], a[44:47]
    s_branch MDONE_58
MT_63:
    s_waitcnt lgkmcnt(0)
    v_mfma_f32_16x16x32_bf16 a[48:51], v[36:39], v[40:43], a[48:51]
    v_mfma_f32_16x16x32_bf16 a[52:55], v[36:39], v[44:47], a[52:55]
    v_mfma_f32_16x16x32_bf16 a[56:59], v[36:39], v[48:51], a[56:59]
    ds_read_b64_tr_b16 v[36:37], v4 offset:1024
    ds_read_b64_tr_b16 v[38:39], v4 offset:1056
    ds_read_b64_tr_b16 v[40:41], v54 offset:256
    ds_read_b64_tr_b16 v[42:43], v55 offset:264
    ds_read_b64_tr_b16 v[44:45], v54 offset:768
    ds_read_b64_tr_b16 v[46:47], v55 offset:776
    ds_read_b64_tr_b16 v[48:49], v54 offset:1280
    ds_read_b64_tr_b16 v[50:51], v55 offset:1288
    s_waitcnt lgkmcnt(0)
    v_mfma_f32_16x16x32_bf16 a[48:51], v[36:39], v[40:43], a[48:51]
    v_mfma_f32_16x16x32_bf16 a[52:55], v[36:39], v[44:47], a[52:55]
    v_mfma_f32_16x16x32_bf16 a[56:59], v[36:39], v[48:51], a[56:59]
    s_branch MDONE_58
MT_59:
    s_cmp_ge_u32 s44, 7
    s_cbranch_scc1 MT_64
    s_cmp_ge_u32 s44, 6
    s_cbranch_scc1 MT_65
    s_waitcnt lgkmcnt(0)
    v_mfma_f32_16x16x32_bf16 a[60:63], v[36:39], v[40:43], a[60:63]
    v_mfma_f32_16x16x32_bf16 a[64:67], v[36:39], v[44:47], a[64:67]
    v_mfma_f32_16x16x32_bf16 a[68:71], v[36:39], v[48:51], a[68:71]
    ds_read_b64_tr_b16 v[36:37], v4 offset:1024
    ds_read_b64_tr_b16 v[38:39], v4 offset:1056
    ds_read_b64_tr_b16 v[40:41], v54 offset:256
    ds_read_b64_tr_b16 v[42:43], v55 offset:264
    ds_read_b64_tr_b16 v[44:45], v54 offset:768
    ds_read_b64_tr_b16 v[46:47], v55 offset:776
    ds_read_b64_tr_b16 v[48:49], v54 offset:1280
    ds_read_b64_tr_b16 v[50:51], v55 offset:1288
    s_waitcnt lgkmcnt(0)
    v_mfma_f32_16x16x32_bf16 a[60:63], v[36:39], v[40:43], a[60:63]
    v_mfma_f32_16x16x32_bf16 a[64:67], v[36:39], v[44:47], a[64:67]
    v_mfma_f32_16x16x32_bf16 a[68:71], v[36:39], v[48:51], a[68:71]
    s_branch MDONE_58
MT_65:
    s_waitcnt lgkmcnt(0)
    v_mfma_f32_16x16x32_bf16 a[72:75], v[36:39], v[40:43], a[72:75]
    v_mfma_f32_16x16x32_bf16 a[76:79], v[36:39], v[44:47], a[76:79]
    v_mfma_f32_16x16x32_bf16 a[80:83], v[36:39], v[48:51], a[80:83]
    ds_read_b64_tr_b16 v[36:37], v4 offset:1024
    ds_read_b64_tr_b16 v[38:39], v4 offset:1056
    ds_read_b64_tr_b16 v[40:41], v54 offset:256
    ds_read_b64_tr_b16 v[42:43], v55 offset:264
    ds_read_b64_tr_b16 v[44:45], v54 offset:768
    ds_read_b64_tr_b16 v[46:47], v55 offset:776
    ds_read_b64_tr_b16 v[48:49], v54 offset:1280
    ds_read_b64_tr_b16 v[50:51], v55 offset:1288
    s_waitcnt lgkmcnt(0)
    v_mfma_f32_16x16x32_bf16 a[72:75], v[36:39], v[40:43], a[72:75]
    v_mfma_f32_16x16x32_bf16 a[76:79], v[36:39], v[44:47], a[76:79]
    v_mfma_f32_16x16x32_bf16 a[80:83], v[36:39], v[48:51], a[80:83]
    s_branch MDONE_58
MT_64:
    s_cmp_ge_u32 s44, 8
    s_cbranch_scc1 MT_66
    s_waitcnt lgkmcnt(0)
    v_mfma_f32_16x16x32_bf16 a[84:87], v[36:39], v[40:43], a[84:87]
    v_mfma_f32_16x16x32_bf16 a[88:91], v[36:39], v[44:47], a[88:91]
    v_mfma_f32_16x16x32_bf16 a[92:95], v[36:39], v[48:51], a[92:95]
    ds_read_b64_tr_b16 v[36:37], v4 offset:1024
    ds_read_b64_tr_b16 v[38:39], v4 offset:1056
    ds_read_b64_tr_b16 v[40:41], v54 offset:256
    ds_read_b64_tr_b16 v[42:43], v55 offset:264
    ds_read_b64_tr_b16 v[44:45], v54 offset:768
    ds_read_b64_tr_b16 v[46:47], v55 offset:776
    ds_read_b64_tr_b16 v[48:49], v54 offset:1280
    ds_read_b64_tr_b16 v[50:51], v55 offset:1288
    s_waitcnt lgkmcnt(0)
    v_mfma_f32_16x16x32_bf16 a[84:87], v[36:39], v[40:43], a[84:87]
    v_mfma_f32_16x16x32_bf16 a[88:91], v[36:39], v[44:47], a[88:91]
    v_mfma_f32_16x16x32_bf16 a[92:95], v[36:39], v[48:51], a[92:95]
    s_branch MDONE_58
MT_66:
    s_waitcnt lgkmcnt(0)
    v_mfma_f32_16x16x32_bf16 a[96:99], v[36:39], v[40:43], a[96:99]
    v_mfma_f32_16x16x32_bf16 a[100:103], v[36:39], v[44:47], a[100:103]
    v_mfma_f32_16x16x32_bf16 a[104:107], v[36:39], v[48:51], a[104:107]
    ds_read_b64_tr_b16 v[36:37], v4 offset:1024
    ds_read_b64_tr_b16 v[38:39], v4 offset:1056
    ds_read_b64_tr_b16 v[40:41], v54 offset:256
    ds_read_b64_tr_b16 v[42:43], v55 offset:264
    ds_read_b64_tr_b16 v[44:45], v54 offset:768
    ds_read_b64_tr_b16 v[46:47], v55 offset:776
    ds_read_b64_tr_b16 v[48:49], v54 offset:1280
    ds_read_b64_tr_b16 v[50:51], v55 offset:1288
    s_waitcnt lgkmcnt(0)
    v_mfma_f32_16x16x32_bf16 a[96:99], v[36:39], v[40:43], a[96:99]
    v_mfma_f32_16x16x32_bf16 a[100:103], v[36:39], v[44:47], a[100:103]
    v_mfma_f32_16x16x32_bf16 a[104:107], v[36:39], v[48:51], a[104:107]
MDONE_58:
AFTER_53:
    s_bitset0_b32 s43, 0
    s_cmp_eq_u32 s50, -1
    s_cbranch_scc1 INVAL_54
    s_lshl_b32 s66, s50, 8
    s_and_b32 s66, s66, 0x80000000
    v_bitop3_b32 v52, v24, v25, s66 bitop3:0x7e
    v_mov_b32 v53, 64
    v_cmp_gt_i32 vcc, 0, v52
    s_cmp_lg_u64 vcc, 0
    s_cbranch_scc1 INVAL_54
    s_cmp_ge_u32 s50, 0xffc00000
    s_cbranch_scc1 WRAP_56
WRAPB_57:
    s_lshl_b64 exec, 1, s54
    ds_add_u32 v9, v53 offset:25088
    s_mov_b64 exec, -1
    s_add_u32 m0, s71, 0
    v_and_or_b32 v52, v24, s38, v3
    v_and_or_b32 v53, v25, s38, v3
    buffer_load_dwordx4 v52, s[8:11], 0 offen lds
    s_add_u32 m0, s71, 1024
    v_mov_b32 v28, v24
    buffer_load_dwordx4 v53, s[8:11], 0 offen lds
    v_mov_b32 v29, v25
    v_mov_b32 v30, v26
    v_mov_b32 v31, v27
    s_bitset1_b32 s43, 0
    s_mov_b32 s44, s54
FIN_55:
    s_cmp_eq_u32 s51, -1
    s_cbranch_scc1 NOPICK_67
    s_and_b32 s66, s51, 0xffff
    s_lshr_b32 s67, s66, 1
    v_add_u32 v25, s66, v0
    v_add_u32 v26, s66, v1
    v_add_u32 v27, s67, v2
    ds_read_b32 v24, v25 offset:25728
    ds_read_b32 v25, v25 offset:25856
    ds_read_b32 v26, v26 offset:25728
    ds_read_u16_d16_hi v27, v27 offset:0
NOPICK_67:
    s_bitcmp1_b32 s43, 1
    s_cbranch_scc0 NOOLD_68
    v_mul_f32 v40, 0.15915494, v35
    v_mul_f32 v42, 0x40400000, v35
    v_fract_f32 v40, v40
    v_cvt_pk_bf16_f32 v42, 0, v42
    v_cos_f32 v40, v40
    v_mul_f32 v42, 0.15915494, v42
    v_and_b32_sdwa v38, 12, v32 dst_sel:WORD_1 dst_unused:UNUSED_PAD src0_sel:DWORD src1_sel:BYTE_0
    v_fract_f32 v42, v42
    v_lshlrev_b32 v43, 4, v34
    v_xor_b32_dpp v52, v38, v6 quad_perm:[0,0,0,0] row_mask:0xf bank_mask:0xf
    v_xor_b32_dpp v53, v38, v6 quad_perm:[2,2,2,2] row_mask:0xf bank_mask:0xf
    v_and_b32_sdwa v38, 12, v33 dst_sel:WORD_1 dst_unused:UNUSED_PAD src0_sel:DWORD src1_sel:BYTE_0
    v_cos_f32 v42, v42
    v_add_f32 v41, v40, v40
    v_xor_b32_dpp v54, v38, v6 quad_perm:[0,0,0,0] row_mask:0xf bank_mask:0xf
    v_xor_b32_dpp v55, v38, v6 quad_perm:[2,2,2,2] row_mask:0xf bank_mask:0xf
    v_cvt_pk_bf16_f32 v16, v40, 0
    v_fma_f32 v41, v41, v40, -1.0
    v_lshlrev_b64 v[44:45], v43, v[16:17]
    v_cvt_pk_bf16_f32 v16, v41, 0
    ds_write_b64 v7, v[44:45]
    v_lshlrev_b64 v[46:47], v43, v[16:17]
    v_cvt_pk_bf16_f32 v16, v42, 0
    ds_write_b64 v7, v[46:47] offset:512
    v_lshlrev_b64 v[48:49], v43, v[16:17]
    v_add_u32 v52, v52, v5
    v_add_u32 v53, v53, v5
    v_add_u32 v54, v54, v5
    v_add_u32 v55, v55, v5
    ds_write_b64 v7, v[48:49] offset:1024
    s_waitcnt vmcnt(3)
    ds_read_b64_tr_b16 v[36:37], v4 offset:2048
    ds_read_b64_tr_b16 v[38:39], v4 offset:2080
    ds_read_b64_tr_b16 v[40:41], v52 offset:0
    ds_read_b64_tr_b16 v[42:43], v53 offset:8
    ds_read_b64_tr_b16 v[44:45], v52 offset:512
    ds_read_b64_tr_b16 v[46:47], v53 offset:520
    ds_read_b64_tr_b16 v[48:49], v52 offset:1024
    ds_read_b64_tr_b16 v[50:51], v53 offset:1032
    s_cmp_ge_u32 s45, 5
    s_cbranch_scc1 MT_75
    s_cmp_ge_u32 s45, 3
    s_cbranch_scc1 MT_76
    s_cmp_ge_u32 s45, 2
    s_cbranch_scc1 MT_77
    s_cmp_ge_u32 s45, 1
    s_cbranch_scc1 MT_78
    s_waitcnt lgkmcnt(0)
    v_mfma_f32_16x16x32_bf16 a[0:3], v[36:39], v[40:43], a[0:3]
    v_mfma_f32_16x16x32_bf16 a[4:7], v[36:39], v[44:47], a[4:7]
    v_mfma_f32_16x16x32_bf16 a[8:11], v[36:39], v[48:51], a[8:11]
    ds_read_b64_tr_b16 v[36:37], v4 offset:3072
    ds_read_b64_tr_b16 v[38:39], v4 offset:3104
    ds_read_b64_tr_b16 v[40:41], v54 offset:256
    ds_read_b64_tr_b16 v[42:43], v55 offset:264
    ds_read_b64_tr_b16 v[44:45], v54 offset:768
    ds_read_b64_tr_b16 v[46:47], v55 offset:776
    ds_read_b64_tr_b16 v[48:49], v54 offset:1280
    ds_read_b64_tr_b16 v[50:51], v55 offset:1288
    s_waitcnt lgkmcnt(0)
    v_mfma_f32_16x16x32_bf16 a[0:3], v[36:39], v[40:43], a[0:3]
    v_mfma_f32_16x16x32_bf16 a[4:7], v[36:39], v[44:47], a[4:7]
    v_mfma_f32_16x16x32_bf16 a[8:11], v[36:39], v[48:51], a[8:11]
    s_branch MDONE_74
MT_78:
    s_waitcnt lgkmcnt(0)
    v_mfma_f32_16x16x32_bf16 a[12:15], v[36:39], v[40:43], a[12:15]
    v_mfma_f32_16x16x32_bf16 a[16:19], v[36:39], v[44:47], a[16:19]
    v_mfma_f32_16x16x32_bf16 a[20:23], v[36:39], v[48:51], a[20:23]
    ds_read_b64_tr_b16 v[36:37], v4 offset:3072
    ds_read_b64_tr_b16 v[38:39], v4 offset:3104
    ds_read_b64_tr_b16 v[40:41], v54 offset:256
    ds_read_b64_tr_b16 v[42:43], v55 offset:264
    ds_read_b64_tr_b16 v[44:45], v54 offset:768
    ds_read_b64_tr_b16 v[46:47], v55 offset:776
    ds_read_b64_tr_b16 v[48:49], v54 offset:1280
    ds_read_b64_tr_b16 v[50:51], v55 offset:1288
    s_waitcnt lgkmcnt(0)
    v_mfma_f32_16x16x32_bf16 a[12:15], v[36:39], v[40:43], a[12:15]
    v_mfma_f32_16x16x32_bf16 a[16:19], v[36:39], v[44:47], a[16:19]
    v_mfma_f32_16x16x32_bf16 a[20:23], v[36:39], v[48:51], a[20:23]
    s_branch MDONE_74
MT_77:
    s_waitcnt lgkmcnt(0)
    v_mfma_f32_16x16x32_bf16 a[24:27], v[36:39], v[40:43], a[24:27]
    v_mfma_f32_16x16x32_bf16 a[28:31], v[36:39], v[44:47], a[28:31]
    v_mfma_f32_16x16x32_bf16 a[32:35], v[36:39], v[48:51], a[32:35]
    ds_read_b64_tr_b16 v[36:37], v4 offset:3072
    ds_read_b64_tr_b16 v[38:39], v4 offset:3104
    ds_read_b64_tr_b16 v[40:41], v54 offset:256
    ds_read_b64_tr_b16 v[42:43], v55 offset:264
    ds_read_b64_tr_b16 v[44:45], v54 offset:768
    ds_read_b64_tr_b16 v[46:47], v55 offset:776
    ds_read_b64_tr_b16 v[48:49], v54 offset:1280
    ds_read_b64_tr_b16 v[50:51], v55 offset:1288
    s_waitcnt lgkmcnt(0)
    v_mfma_f32_16x16x32_bf16 a[24:27], v[36:39], v[40:43], a[24:27]
    v_mfma_f32_16x16x32_bf16 a[28:31], v[36:39], v[44:47], a[28:31]
    v_mfma_f32_16x16x32_bf16 a[32:35], v[36:39], v[48:51], a[32:35]
    s_branch MDONE_74
MT_76:
    s_cmp_ge_u32 s45, 4
    s_cbranch_scc1 MT_79
    s_waitcnt lgkmcnt(0)
    v_mfma_f32_16x16x32_bf16 a[36:39], v[36:39], v[40:43], a[36:39]
    v_mfma_f32_16x16x32_bf16 a[40:43], v[36:39], v[44:47], a[40:43]
    v_mfma_f32_16x16x32_bf16 a[44:47], v[36:39], v[48:51], a[44:47]
    ds_read_b64_tr_b16 v[36:37], v4 offset:3072
    ds_read_b64_tr_b16 v[38:39], v4 offset:3104
    ds_read_b64_tr_b16 v[40:41], v54 offset:256
    ds_read_b64_tr_b16 v[42:43], v55 offset:264
    ds_read_b64_tr_b16 v[44:45], v54 offset:768
    ds_read_b64_tr_b16 v[46:47], v55 offset:776
    ds_read_b64_tr_b16 v[48:49], v54 offset:1280
    ds_read_b64_tr_b16 v[50:51], v55 offset:1288
    s_waitcnt lgkmcnt(0)
    v_mfma_f32_16x16x32_bf16 a[36:39], v[36:39], v[40:43], a[36:39]
    v_mfma_f32_16x16x32_bf16 a[40:43], v[36:39], v[44:47], a[40:43]
    v_mfma_f32_16x16x32_bf16 a[44:47], v[36:39], v[48:51], a[44:47]
    s_branch MDONE_74
MT_79:
    s_waitcnt lgkmcnt(0)
    v_mfma_f32_16x16x32_bf16 a[48:51], v[36:39], v[40:43], a[48:51]
    v_mfma_f32_16x16x32_bf16 a[52:55], v[36:39], v[44:47], a[52:55]
    v_mfma_f32_16x16x32_bf16 a[56:59], v[36:39], v[48:51], a[56:59]
    ds_read_b64_tr_b16 v[36:37], v4 offset:3072
    ds_read_b64_tr_b16 v[38:39], v4 offset:3104
    ds_read_b64_tr_b16 v[40:41], v54 offset:256
    ds_read_b64_tr_b16 v[42:43], v55 offset:264
    ds_read_b64_tr_b16 v[44:45], v54 offset:768
    ds_read_b64_tr_b16 v[46:47], v55 offset:776
    ds_read_b64_tr_b16 v[48:49], v54 offset:1280
    ds_read_b64_tr_b16 v[50:51], v55 offset:1288
    s_waitcnt lgkmcnt(0)
    v_mfma_f32_16x16x32_bf16 a[48:51], v[36:39], v[40:43], a[48:51]
    v_mfma_f32_16x16x32_bf16 a[52:55], v[36:39], v[44:47], a[52:55]
    v_mfma_f32_16x16x32_bf16 a[56:59], v[36:39], v[48:51], a[56:59]
    s_branch MDONE_74
MT_75:
    s_cmp_ge_u32 s45, 7
    s_cbranch_scc1 MT_80
    s_cmp_ge_u32 s45, 6
    s_cbranch_scc1 MT_81
    s_waitcnt lgkmcnt(0)
    v_mfma_f32_16x16x32_bf16 a[60:63], v[36:39], v[40:43], a[60:63]
    v_mfma_f32_16x16x32_bf16 a[64:67], v[36:39], v[44:47], a[64:67]
    v_mfma_f32_16x16x32_bf16 a[68:71], v[36:39], v[48:51], a[68:71]
    ds_read_b64_tr_b16 v[36:37], v4 offset:3072
    ds_read_b64_tr_b16 v[38:39], v4 offset:3104
    ds_read_b64_tr_b16 v[40:41], v54 offset:256
    ds_read_b64_tr_b16 v[42:43], v55 offset:264
    ds_read_b64_tr_b16 v[44:45], v54 offset:768
    ds_read_b64_tr_b16 v[46:47], v55 offset:776
    ds_read_b64_tr_b16 v[48:49], v54 offset:1280
    ds_read_b64_tr_b16 v[50:51], v55 offset:1288
    s_waitcnt lgkmcnt(0)
    v_mfma_f32_16x16x32_bf16 a[60:63], v[36:39], v[40:43], a[60:63]
    v_mfma_f32_16x16x32_bf16 a[64:67], v[36:39], v[44:47], a[64:67]
    v_mfma_f32_16x16x32_bf16 a[68:71], v[36:39], v[48:51], a[68:71]
    s_branch MDONE_74
MT_81:
    s_waitcnt lgkmcnt(0)
    v_mfma_f32_16x16x32_bf16 a[72:75], v[36:39], v[40:43], a[72:75]
    v_mfma_f32_16x16x32_bf16 a[76:79], v[36:39], v[44:47], a[76:79]
    v_mfma_f32_16x16x32_bf16 a[80:83], v[36:39], v[48:51], a[80:83]
    ds_read_b64_tr_b16 v[36:37], v4 offset:3072
    ds_read_b64_tr_b16 v[38:39], v4 offset:3104
    ds_read_b64_tr_b16 v[40:41], v54 offset:256
    ds_read_b64_tr_b16 v[42:43], v55 offset:264
    ds_read_b64_tr_b16 v[44:45], v54 offset:768
    ds_read_b64_tr_b16 v[46:47], v55 offset:776
    ds_read_b64_tr_b16 v[48:49], v54 offset:1280
    ds_read_b64_tr_b16 v[50:51], v55 offset:1288
    s_waitcnt lgkmcnt(0)
    v_mfma_f32_16x16x32_bf16 a[72:75], v[36:39], v[40:43], a[72:75]
    v_mfma_f32_16x16x32_bf16 a[76:79], v[36:39], v[44:47], a[76:79]
    v_mfma_f32_16x16x32_bf16 a[80:83], v[36:39], v[48:51], a[80:83]
    s_branch MDONE_74
MT_80:
    s_cmp_ge_u32 s45, 8
    s_cbranch_scc1 MT_82
    s_waitcnt lgkmcnt(0)
    v_mfma_f32_16x16x32_bf16 a[84:87], v[36:39], v[40:43], a[84:87]
    v_mfma_f32_16x16x32_bf16 a[88:91], v[36:39], v[44:47], a[88:91]
    v_mfma_f32_16x16x32_bf16 a[92:95], v[36:39], v[48:51], a[92:95]
    ds_read_b64_tr_b16 v[36:37], v4 offset:3072
    ds_read_b64_tr_b16 v[38:39], v4 offset:3104
    ds_read_b64_tr_b16 v[40:41], v54 offset:256
    ds_read_b64_tr_b16 v[42:43], v55 offset:264
    ds_read_b64_tr_b16 v[44:45], v54 offset:768
    ds_read_b64_tr_b16 v[46:47], v55 offset:776
    ds_read_b64_tr_b16 v[48:49], v54 offset:1280
    ds_read_b64_tr_b16 v[50:51], v55 offset:1288
    s_waitcnt lgkmcnt(0)
    v_mfma_f32_16x16x32_bf16 a[84:87], v[36:39], v[40:43], a[84:87]
    v_mfma_f32_16x16x32_bf16 a[88:91], v[36:39], v[44:47], a[88:91]
    v_mfma_f32_16x16x32_bf16 a[92:95], v[36:39], v[48:51], a[92:95]
    s_branch MDONE_74
MT_82:
    s_waitcnt lgkmcnt(0)
    v_mfma_f32_16x16x32_bf16 a[96:99], v[36:39], v[40:43], a[96:99]
    v_mfma_f32_16x16x32_bf16 a[100:103], v[36:39], v[44:47], a[100:103]
    v_mfma_f32_16x16x32_bf16 a[104:107], v[36:39], v[48:51], a[104:107]
    ds_read_b64_tr_b16 v[36:37], v4 offset:3072
    ds_read_b64_tr_b16 v[38:39], v4 offset:3104
    ds_read_b64_tr_b16 v[40:41], v54 offset:256
    ds_read_b64_tr_b16 v[42:43], v55 offset:264
    ds_read_b64_tr_b16 v[44:45], v54 offset:768
    ds_read_b64_tr_b16 v[46:47], v55 offset:776
    ds_read_b64_tr_b16 v[48:49], v54 offset:1280
    ds_read_b64_tr_b16 v[50:51], v55 offset:1288
    s_waitcnt lgkmcnt(0)
    v_mfma_f32_16x16x32_bf16 a[96:99], v[36:39], v[40:43], a[96:99]
    v_mfma_f32_16x16x32_bf16 a[100:103], v[36:39], v[44:47], a[100:103]
    v_mfma_f32_16x16x32_bf16 a[104:107], v[36:39], v[48:51], a[104:107]
MDONE_74:
AFTER_69:
    s_bitset0_b32 s43, 1
    s_cmp_eq_u32 s51, -1
    s_cbranch_scc1 INVAL_70
    s_lshl_b32 s66, s51, 8
    s_and_b32 s66, s66, 0x80000000
    v_bitop3_b32 v52, v24, v25, s66 bitop3:0x7e
    v_mov_b32 v53, 64
    v_cmp_gt_i32 vcc, 0, v52
    s_cmp_lg_u64 vcc, 0
    s_cbranch_scc1 INVAL_70
    s_cmp_ge_u32 s51, 0xffc00000
    s_cbranch_scc1 WRAP_72
WRAPB_73:
    s_lshl_b64 exec, 1, s55
    ds_add_u32 v9, v53 offset:25088
    s_mov_b64 exec, -1
    s_add_u32 m0, s71, 2048
    v_and_or_b32 v52, v24, s38, v3
    v_and_or_b32 v53, v25, s38, v3
    buffer_load_dwordx4 v52, s[8:11], 0 offen lds
    s_add_u32 m0, s71, 3072
    v_mov_b32 v32, v24
    buffer_load_dwordx4 v53, s[8:11], 0 offen lds
    v_mov_b32 v33, v25
    v_mov_b32 v34, v26
    v_mov_b32 v35, v27
    s_bitset1_b32 s43, 1
    s_mov_b32 s45, s55
FIN_71:
    s_cmp_lt_u32 s37, 12
    s_cbranch_scc1 CONT_83
    s_cmp_eq_u32 s43, 0
    s_cbranch_scc1 P2_EPOCH
CONT_83:
    s_cmp_eq_u32 s60, 0
    s_cbranch_scc1 NOSLEEP_84
    s_cmp_lg_u32 s43, 0
    s_cbranch_scc1 NOSLEEP_84
    s_sleep 16
NOSLEEP_84:
    s_add_u32 s88, s88, 1
    s_cmp_gt_u32 s88, 16777216
    s_cbranch_scc1 P2_FLUSH
    s_cmp_lg_u32 s60, 0
    s_cbranch_scc1 DRAIN_91
    s_waitcnt vmcnt(9)
    v_readlane_b32 s40, v10, 14
    s_lshr_b32 s40, s40, 11
    v_add_u32 v57, s40, v21
    ds_read_b32 v58, v57
    ds_read_b32 v59, v9 offset:25088
    v_lshlrev_b32_sdwa v54, 2, v18 dst_sel:DWORD dst_unused:UNUSED_PAD src0_sel:DWORD src1_sel:BYTE_3
    v_lshlrev_b32_sdwa v55, 2, v19 dst_sel:DWORD dst_unused:UNUSED_PAD src0_sel:DWORD src1_sel:BYTE_3
    v_mov_b32 v52, 0x10000
    s_cmp_lg_u32 s36, 0
    s_cbranch_scc1 RETRYRD_86
    s_mov_b64 exec, s[32:33]
    ds_add_rtn_u32 v22, v54, v52 offset:25088
    s_mov_b64 exec, s[34:35]
    ds_add_rtn_u32 v23, v55, v52 offset:25088
COMMON_87:
    s_waitcnt lgkmcnt(0)
    s_mov_b64 exec, s[32:33]
    v_sub_u16_sdwa v36, v22, v22 dst_sel:DWORD dst_unused:UNUSED_PAD src0_sel:WORD_1 src1_sel:WORD_0
    v_lshrrev_b32 v37, 14, v22
    v_cmpx_gt_u32 vcc, s74, v36
    v_and_b32 v37, 0x1fc, v37
    v_perm_b32 v38, v22, v18, s39
    v_mad_u32_u24 v37, v54, s74, v37
    s_andn2_b64 s[32:33], s[32:33], exec
    v_lshrrev_b32 v36, 1, v37
    ds_write_b16 v36, v20 offset:0
    ds_write_b32 v37, v38 offset:25728
    s_mov_b64 exec, s[34:35]
    v_sub_u16_sdwa v36, v23, v23 dst_sel:DWORD dst_unused:UNUSED_PAD src0_sel:WORD_1 src1_sel:WORD_0
    v_lshrrev_b32 v37, 14, v23
    v_cmpx_gt_u32 vcc, s74, v36
    v_and_b32 v37, 0x1fc, v37
    v_perm_b32 v38, v23, v19, s39
    v_mad_u32_u24 v37, v55, s74, v37
    s_andn2_b64 s[34:35], s[34:35], exec
    v_lshrrev_b32 v36, 1, v37
    ds_write_b16_d16_hi v36, v20 offset:0
    ds_write_b32 v37, v38 offset:25728
    s_mov_b64 exec, -1
    s_or_b64 s[64:65], s[32:33], s[34:35]
    s_cbranch_scc1 PEND_88
    s_mov_b32 s36, 0
    v_bfe_u32 v56, v58, 23, 1
    v_and_b32 v57, 0x7fffff, v58
    v_sub_u32 v56, v8, v56
    v_mad_u32_u24 v57, v57, 12, v15
    v_cmp_lt_u32_sdwa s[32:33], v56, v58 src0_sel:DWORD src1_sel:BYTE_3
    v_add_u32 v56, 1, v56
    v_cmp_lt_u32_sdwa s[34:35], v56, v58 src0_sel:DWORD src1_sel:BYTE_3
    s_or_b64 s[64:65], s[32:33], s[34:35]
    v_cndmask_b32_e64 v57, -16, v57, s[64:65]
    buffer_load_dwordx3 v[18:20], v57, s[12:15], 0 offen
    s_mov_b64 exec, 0x4000
    ds_add_rtn_u32 v10, v9, v52 offset:25088
    s_mov_b64 exec, -1
ISSUED_89:
    s_cmp_lt_u32 s40, s41
    s_cbranch_scc1 NODONE_90
    s_or_b64 s[64:65], s[28:29], s[30:31]
    s_or_b64 s[64:65], s[64:65], s[32:33]
    s_or_b64 s[64:65], s[64:65], s[34:35]
    s_cbranch_scc1 NODONE_90
    s_cmp_lg_u32 s36, 0
    s_cbranch_scc1 NODONE_90
    s_mov_b32 s60, 1
    s_mov_b32 s79, s88
    s_setprio 0
    s_mov_b64 exec, 1
    v_mov_b32 v36, 25596
    v_mov_b32 v37, 1
    ds_add_u32 v36, v37
    s_mov_b64 exec, -1
NODONE_90:
POLL_92:
    v_readlane_b32 s37, v59, 15
    v_mov_b32 v37, -1
    s_mov_b64 exec, s[62:63]
    v_sub_u16_sdwa v36, v59, v59 dst_sel:DWORD dst_unused:UNUSED_PAD src0_sel:WORD_1 src1_sel:WORD_0
    v_lshlrev_b32 v37, 7, v9
    v_and_b32 v38, 64, v59
    v_lshl_add_u32 v37, v38, 2, v37
    v_lshl_or_b32 v37, v59, 16, v37
    v_cmp_le_u32 vcc, 64, v36
    s_mov_b32 s58, vcc_lo
    v_cmp_le_u32 vcc, 0x60, v36
    s_andn2_b32 s58, s58, vcc_lo
    s_lshl_b32 s58, s58, 16
    s_or_b32 s58, s58, vcc_lo
    s_ff1_i32_b32 s59, s58
    s_bitset0_b32 s58, s59
    s_and_b32 s54, s59, 15
    v_readlane_b32 s50, v37, s54
    s_ff1_i32_b32 s59, s58
    s_bitset0_b32 s58, s59
    s_and_b32 s55, s59, 15
    v_readlane_b32 s51, v37, s55
    s_mov_b64 exec, -1
    s_cmp_eq_u32 s50, -1
    s_cbranch_scc1 NOPICK_93
    s_and_b32 s66, s50, 0xffff
    s_lshr_b32 s67, s66, 1
    v_add_u32 v25, s66, v0
    v_add_u32 v26, s66, v1
    v_add_u32 v27, s67, v2
    ds_read_b32 v24, v25 offset:25728
    ds_read_b32 v25, v25 offset:25856
    ds_read_b32 v26, v26 offset:25728
    ds_read_u16_d16_hi v27, v27 offset:0
NOPICK_93:
    s_bitcmp1_b32 s43, 0
    s_cbranch_scc0 NOOLD_94
    v_mul_f32 v40, 0.15915494, v31
    v_mul_f32 v42, 0x40400000, v31
    v_fract_f32 v40, v40
    v_cvt_pk_bf16_f32 v42, 0, v42
    v_cos_f32 v40, v40
    v_mul_f32 v42, 0.15915494, v42
    v_and_b32_sdwa v38, 12, v28 dst_sel:WORD_1 dst_unused:UNUSED_PAD src0_sel:DWORD src1_sel:BYTE_0
    v_fract_f32 v42, v42
    v_lshlrev_b32 v43, 4, v30
    v_xor_b32_dpp v52, v38, v6 quad_perm:[0,0,0,0] row_mask:0xf bank_mask:0xf
    v_xor_b32_dpp v53, v38, v6 quad_perm:[2,2,2,2] row_mask:0xf bank_mask:0xf
    v_and_b32_sdwa v38, 12, v29 dst_sel:WORD_1 dst_unused:UNUSED_PAD src0_sel:DWORD src1_sel:BYTE_0
    v_cos_f32 v42, v42
    v_add_f32 v41, v40, v40
    v_xor_b32_dpp v54, v38, v6 quad_perm:[0,0,0,0] row_mask:0xf bank_mask:0xf
    v_xor_b32_dpp v55, v38, v6 quad_perm:[2,2,2,2] row_mask:0xf bank_mask:0xf
    v_cvt_pk_bf16_f32 v16, v40, 0
    v_fma_f32 v41, v41, v40, -1.0
    v_lshlrev_b64 v[44:45], v43, v[16:17]
    v_cvt_pk_bf16_f32 v16, v41, 0
    ds_write_b64 v7, v[44:45]
    v_lshlrev_b64 v[46:47], v43, v[16:17]
    v_cvt_pk_bf16_f32 v16, v42, 0
    ds_write_b64 v7, v[46:47] offset:512
    v_lshlrev_b64 v[48:49], v43, v[16:17]
    v_add_u32 v52, v52, v5
    v_add_u32 v53, v53, v5
    v_add_u32 v54, v54, v5
    v_add_u32 v55, v55, v5
    ds_write_b64 v7, v[48:49] offset:1024
    s_waitcnt vmcnt(3)
    ds_read_b64_tr_b16 v[36:37], v4 offset:0
    ds_read_b64_tr_b16 v[38:39], v4 offset:32
    ds_read_b64_tr_b16 v[40:41], v52 offset:0
    ds_read_b64_tr_b16 v[42:43], v53 offset:8
    ds_read_b64_tr_b16 v[44:45], v52 offset:512
    ds_read_b64_tr_b16 v[46:47], v53 offset:520
    ds_read_b64_tr_b16 v[48:49], v52 offset:1024
    ds_read_b64_tr_b16 v[50:51], v53 offset:1032
    s_cmp_ge_u32 s44, 5
    s_cbranch_scc1 MT_101
    s_cmp_ge_u32 s44, 3
    s_cbranch_scc1 MT_102
    s_cmp_ge_u32 s44, 2
    s_cbranch_scc1 MT_103
    s_cmp_ge_u32 s44, 1
    s_cbranch_scc1 MT_104
    s_waitcnt lgkmcnt(0)
    v_mfma_f32_16x16x32_bf16 a[0:3], v[36:39], v[40:43], a[0:3]
    v_mfma_f32_16x16x32_bf16 a[4:7], v[36:39], v[44:47], a[4:7]
    v_mfma_f32_16x16x32_bf16 a[8:11], v[36:39], v[48:51], a[8:11]
    ds_read_b64_tr_b16 v[36:37], v4 offset:1024
    ds_read_b64_tr_b16 v[38:39], v4 offset:1056
    ds_read_b64_tr_b16 v[40:41], v54 offset:256
    ds_read_b64_tr_b16 v[42:43], v55 offset:264
    ds_read_b64_tr_b16 v[44:45], v54 offset:768
    ds_read_b64_tr_b16 v[46:47], v55 offset:776
    ds_read_b64_tr_b16 v[48:49], v54 offset:1280
    ds_read_b64_tr_b16 v[50:51], v55 offset:1288
    s_waitcnt lgkmcnt(0)
    v_mfma_f32_16x16x32_bf16 a[0:3], v[36:39], v[40:43], a[0:3]
    v_mfma_f32_16x16x32_bf16 a[4:7], v[36:39], v[44:47], a[4:7]
    v_mfma_f32_16x16x32_bf16 a[8:11], v[36:39], v[48:51], a[8:11]
    s_branch MDONE_100
MT_104:
    s_waitcnt lgkmcnt(0)
    v_mfma_f32_16x16x32_bf16 a[12:15], v[36:39], v[40:43], a[12:15]
    v_mfma_f32_16x16x32_bf16 a[16:19], v[36:39], v[44:47], a[16:19]
    v_mfma_f32_16x16x32_bf16 a[20:23], v[36:39], v[48:51], a[20:23]
    ds_read_b64_tr_b16 v[36:37], v4 offset:1024
    ds_read_b64_tr_b16 v[38:39], v4 offset:1056
    ds_read_b64_tr_b16 v[40:41], v54 offset:256
    ds_read_b64_tr_b16 v[42:43], v55 offset:264
    ds_read_b64_tr_b16 v[44:45], v54 offset:768
    ds_read_b64_tr_b16 v[46:47], v55 offset:776
    ds_read_b64_tr_b16 v[48:49], v54 offset:1280
    ds_read_b64_tr_b16 v[50:51], v55 offset:1288
    s_waitcnt lgkmcnt(0)
    v_mfma_f32_16x16x32_bf16 a[12:15], v[36:39], v[40:43], a[12:15]
    v_mfma_f32_16x16x32_bf16 a[16:19], v[36:39], v[44:47], a[16:19]
    v_mfma_f32_16x16x32_bf16 a[20:23], v[36:39], v[48:51], a[20:23]
    s_branch MDONE_100
MT_103:
    s_waitcnt lgkmcnt(0)
    v_mfma_f32_16x16x32_bf16 a[24:27], v[36:39], v[40:43], a[24:27]
    v_mfma_f32_16x16x32_bf16 a[28:31], v[36:39], v[44:47], a[28:31]
    v_mfma_f32_16x16x32_bf16 a[32:35], v[36:39], v[48:51], a[32:35]
    ds_read_b64_tr_b16 v[36:37], v4 offset:1024
    ds_read_b64_tr_b16 v[38:39], v4 offset:1056
    ds_read_b64_tr_b16 v[40:41], v54 offset:256
    ds_read_b64_tr_b16 v[42:43], v55 offset:264
    ds_read_b64_tr_b16 v[44:45], v54 offset:768
    ds_read_b64_tr_b16 v[46:47], v55 offset:776
    ds_read_b64_tr_b16 v[48:49], v54 offset:1280
    ds_read_b64_tr_b16 v[50:51], v55 offset:1288
    s_waitcnt lgkmcnt(0)
    v_mfma_f32_16x16x32_bf16 a[24:27], v[36:39], v[40:43], a[24:27]
    v_mfma_f32_16x16x32_bf16 a[28:31], v[36:39], v[44:47], a[28:31]
    v_mfma_f32_16x16x32_bf16 a[32:35], v[36:39], v[48:51], a[32:35]
    s_branch MDONE_100
MT_102:
    s_cmp_ge_u32 s44, 4
    s_cbranch_scc1 MT_105
    s_waitcnt lgkmcnt(0)
    v_mfma_f32_16x16x32_bf16 a[36:39], v[36:39], v[40:43], a[36:39]
    v_mfma_f32_16x16x32_bf16 a[40:43], v[36:39], v[44:47], a[40:43]
    v_mfma_f32_16x16x32_bf16 a[44:47], v[36:39], v[48:51], a[44:47]
    ds_read_b64_tr_b16 v[36:37], v4 offset:1024
    ds_read_b64_tr_b16 v[38:39], v4 offset:1056
    ds_read_b64_tr_b16 v[40:41], v54 offset:256
    ds_read_b64_tr_b16 v[42:43], v55 offset:264
    ds_read_b64_tr_b16 v[44:45], v54 offset:768
    ds_read_b64_tr_b16 v[46:47], v55 offset:776
    ds_read_b64_tr_b16 v[48:49], v54 offset:1280
    ds_read_b64_tr_b16 v[50:51], v55 offset:1288
    s_waitcnt lgkmcnt(0)
    v_mfma_f32_16x16x32_bf16 a[36:39], v[36:39], v[40:43], a[36:39]
    v_mfma_f32_16x16x32_bf16 a[40:43], v[36:39], v[44:47], a[40:43]
    v_mfma_f32_16x16x32_bf16 a[44:47], v[36:39], v[48:51], a[44:47]
    s_branch MDONE_100
MT_105:
    s_waitcnt lgkmcnt(0)
    v_mfma_f32_16x16x32_bf16 a[48:51], v[36:39], v[40:43], a[48:51]
    v_mfma_f32_16x16x32_bf16 a[52:55], v[36:39], v[44:47], a[52:55]
    v_mfma_f32_16x16x32_bf16 a[56:59], v[36:39], v[48:51], a[56:59]
    ds_read_b64_tr_b16 v[36:37], v4 offset:1024
    ds_read_b64_tr_b16 v[38:39], v4 offset:1056
    ds_read_b64_tr_b16 v[40:41], v54 offset:256
    ds_read_b64_tr_b16 v[42:43], v55 offset:264
    ds_read_b64_tr_b16 v[44:45], v54 offset:768
    ds_read_b64_tr_b16 v[46:47], v55 offset:776
    ds_read_b64_tr_b16 v[48:49], v54 offset:1280
    ds_read_b64_tr_b16 v[50:51], v55 offset:1288
    s_waitcnt lgkmcnt(0)
    v_mfma_f32_16x16x32_bf16 a[48:51], v[36:39], v[40:43], a[48:51]
    v_mfma_f32_16x16x32_bf16 a[52:55], v[36:39], v[44:47], a[52:55]
    v_mfma_f32_16x16x32_bf16 a[56:59], v[36:39], v[48:51], a[56:59]
    s_branch MDONE_100
MT_101:
    s_cmp_ge_u32 s44, 7
    s_cbranch_scc1 MT_106
    s_cmp_ge_u32 s44, 6
    s_cbranch_scc1 MT_107
    s_waitcnt lgkmcnt(0)
    v_mfma_f32_16x16x32_bf16 a[60:63], v[36:39], v[40:43], a[60:63]
    v_mfma_f32_16x16x32_bf16 a[64:67], v[36:39], v[44:47], a[64:67]
    v_mfma_f32_16x16x32_bf16 a[68:71], v[36:39], v[48:51], a[68:71]
    ds_read_b64_tr_b16 v[36:37], v4 offset:1024
    ds_read_b64_tr_b16 v[38:39], v4 offset:1056
    ds_read_b64_tr_b16 v[40:41], v54 offset:256
    ds_read_b64_tr_b16 v[42:43], v55 offset:264
    ds_read_b64_tr_b16 v[44:45], v54 offset:768
    ds_read_b64_tr_b16 v[46:47], v55 offset:776
    ds_read_b64_tr_b16 v[48:49], v54 offset:1280
    ds_read_b64_tr_b16 v[50:51], v55 offset:1288
    s_waitcnt lgkmcnt(0)
    v_mfma_f32_16x16x32_bf16 a[60:63], v[36:39], v[40:43], a[60:63]
    v_mfma_f32_16x16x32_bf16 a[64:67], v[36:39], v[44:47], a[64:67]
    v_mfma_f32_16x16x32_bf16 a[68:71], v[36:39], v[48:51], a[68:71]
    s_branch MDONE_100
MT_107:
    s_waitcnt lgkmcnt(0)
    v_mfma_f32_16x16x32_bf16 a[72:75], v[36:39], v[40:43], a[72:75]
    v_mfma_f32_16x16x32_bf16 a[76:79], v[36:39], v[44:47], a[76:79]
    v_mfma_f32_16x16x32_bf16 a[80:83], v[36:39], v[48:51], a[80:83]
    ds_read_b64_tr_b16 v[36:37], v4 offset:1024
    ds_read_b64_tr_b16 v[38:39], v4 offset:1056
    ds_read_b64_tr_b16 v[40:41], v54 offset:256
    ds_read_b64_tr_b16 v[42:43], v55 offset:264
    ds_read_b64_tr_b16 v[44:45], v54 offset:768
    ds_read_b64_tr_b16 v[46:47], v55 offset:776
    ds_read_b64_tr_b16 v[48:49], v54 offset:1280
    ds_read_b64_tr_b16 v[50:51], v55 offset:1288
    s_waitcnt lgkmcnt(0)
    v_mfma_f32_16x16x32_bf16 a[72:75], v[36:39], v[40:43], a[72:75]
    v_mfma_f32_16x16x32_bf16 a[76:79], v[36:39], v[44:47], a[76:79]
    v_mfma_f32_16x16x32_bf16 a[80:83], v[36:39], v[48:51], a[80:83]
    s_branch MDONE_100
MT_106:
    s_cmp_ge_u32 s44, 8
    s_cbranch_scc1 MT_108
    s_waitcnt lgkmcnt(0)
    v_mfma_f32_16x16x32_bf16 a[84:87], v[36:39], v[40:43], a[84:87]
    v_mfma_f32_16x16x32_bf16 a[88:91], v[36:39], v[44:47], a[88:91]
    v_mfma_f32_16x16x32_bf16 a[92:95], v[36:39], v[48:51], a[92:95]
    ds_read_b64_tr_b16 v[36:37], v4 offset:1024
    ds_read_b64_tr_b16 v[38:39], v4 offset:1056
    ds_read_b64_tr_b16 v[40:41], v54 offset:256
    ds_read_b64_tr_b16 v[42:43], v55 offset:264
    ds_read_b64_tr_b16 v[44:45], v54 offset:768
    ds_read_b64_tr_b16 v[46:47], v55 offset:776
    ds_read_b64_tr_b16 v[48:49], v54 offset:1280
    ds_read_b64_tr_b16 v[50:51], v55 offset:1288
    s_waitcnt lgkmcnt(0)
    v_mfma_f32_16x16x32_bf16 a[84:87], v[36:39], v[40:43], a[84:87]
    v_mfma_f32_16x16x32_bf16 a[88:91], v[36:39], v[44:47], a[88:91]
    v_mfma_f32_16x16x32_bf16 a[92:95], v[36:39], v[48:51], a[92:95]
    s_branch MDONE_100
MT_108:
    s_waitcnt lgkmcnt(0)
    v_mfma_f32_16x16x32_bf16 a[96:99], v[36:39], v[40:43], a[96:99]
    v_mfma_f32_16x16x32_bf16 a[100:103], v[36:39], v[44:47], a[100:103]
    v_mfma_f32_16x16x32_bf16 a[104:107], v[36:39], v[48:51], a[104:107]
    ds_read_b64_tr_b16 v[36:37], v4 offset:1024
    ds_read_b64_tr_b16 v[38:39], v4 offset:1056
    ds_read_b64_tr_b16 v[40:41], v54 offset:256
    ds_read_b64_tr_b16 v[42:43], v55 offset:264
    ds_read_b64_tr_b16 v[44:45], v54 offset:768
    ds_read_b64_tr_b16 v[46:47], v55 offset:776
    ds_read_b64_tr_b16 v[48:49], v54 offset:1280
    ds_read_b64_tr_b16 v[50:51], v55 offset:1288
    s_waitcnt lgkmcnt(0)
    v_mfma_f32_16x16x32_bf16 a[96:99], v[36:39], v[40:43], a[96:99]
    v_mfma_f32_16x16x32_bf16 a[100:103], v[36:39], v[44:47], a[100:103]
    v_mfma_f32_16x16x32_bf16 a[104:107], v[36:39], v[48:51], a[104:107]
MDONE_100:
AFTER_95:
    s_bitset0_b32 s43, 0
    s_cmp_eq_u32 s50, -1
    s_cbranch_scc1 INVAL_96
    s_lshl_b32 s66, s50, 8
    s_and_b32 s66, s66, 0x80000000
    v_bitop3_b32 v52, v24, v25, s66 bitop3:0x7e
    v_mov_b32 v53, 64
    v_cmp_gt_i32 vcc, 0, v52
    s_cmp_lg_u64 vcc, 0
    s_cbranch_scc1 INVAL_96
    s_cmp_ge_u32 s50, 0xffc00000
    s_cbranch_scc1 WRAP_98
WRAPB_99:
    s_lshl_b64 exec, 1, s54
    ds_add_u32 v9, v53 offset:25088
    s_mov_b64 exec, -1
    s_add_u32 m0, s71, 0
    v_and_or_b32 v52, v24, s38, v3
    v_and_or_b32 v53, v25, s38, v3
    buffer_load_dwordx4 v52, s[8:11], 0 offen lds
    s_add_u32 m0, s71, 1024
    v_mov_b32 v28, v24
    buffer_load_dwordx4 v53, s[8:11], 0 offen lds
    v_mov_b32 v29, v25
    v_mov_b32 v30, v26
    v_mov_b32 v31, v27
    s_bitset1_b32 s43, 0
    s_mov_b32 s44, s54
FIN_97:
    s_cmp_eq_u32 s51, -1
    s_cbranch_scc1 NOPICK_109
    s_and_b32 s66, s51, 0xffff
    s_lshr_b32 s67, s66, 1
    v_add_u32 v25, s66, v0
    v_add_u32 v26, s66, v1
    v_add_u32 v27, s67, v2
    ds_read_b32 v24, v25 offset:25728
    ds_read_b32 v25, v25 offset:25856
    ds_read_b32 v26, v26 offset:25728
    ds_read_u16_d16_hi v27, v27 offset:0
NOPICK_109:
    s_bitcmp1_b32 s43, 1
    s_cbranch_scc0 NOOLD_110
    v_mul_f32 v40, 0.15915494, v35
    v_mul_f32 v42, 0x40400000, v35
    v_fract_f32 v40, v40
    v_cvt_pk_bf16_f32 v42, 0, v42
    v_cos_f32 v40, v40
    v_mul_f32 v42, 0.15915494, v42
    v_and_b32_sdwa v38, 12, v32 dst_sel:WORD_1 dst_unused:UNUSED_PAD src0_sel:DWORD src1_sel:BYTE_0
    v_fract_f32 v42, v42
    v_lshlrev_b32 v43, 4, v34
    v_xor_b32_dpp v52, v38, v6 quad_perm:[0,0,0,0] row_mask:0xf bank_mask:0xf
    v_xor_b32_dpp v53, v38, v6 quad_perm:[2,2,2,2] row_mask:0xf bank_mask:0xf
    v_and_b32_sdwa v38, 12, v33 dst_sel:WORD_1 dst_unused:UNUSED_PAD src0_sel:DWORD src1_sel:BYTE_0
    v_cos_f32 v42, v42
    v_add_f32 v41, v40, v40
    v_xor_b32_dpp v54, v38, v6 quad_perm:[0,0,0,0] row_mask:0xf bank_mask:0xf
    v_xor_b32_dpp v55, v38, v6 quad_perm:[2,2,2,2] row_mask:0xf bank_mask:0xf
    v_cvt_pk_bf16_f32 v16, v40, 0
    v_fma_f32 v41, v41, v40, -1.0
    v_lshlrev_b64 v[44:45], v43, v[16:17]
    v_cvt_pk_bf16_f32 v16, v41, 0
    ds_write_b64 v7, v[44:45]
    v_lshlrev_b64 v[46:47], v43, v[16:17]
    v_cvt_pk_bf16_f32 v16, v42, 0
    ds_write_b64 v7, v[46:47] offset:512
    v_lshlrev_b64 v[48:49], v43, v[16:17]
    v_add_u32 v52, v52, v5
    v_add_u32 v53, v53, v5
    v_add_u32 v54, v54, v5
    v_add_u32 v55, v55, v5
    ds_write_b64 v7, v[48:49] offset:1024
    s_waitcnt vmcnt(3)
    ds_read_b64_tr_b16 v[36:37], v4 offset:2048
    ds_read_b64_tr_b16 v[38:39], v4 offset:2080
    ds_read_b64_tr_b16 v[40:41], v52 offset:0
    ds_read_b64_tr_b16 v[42:43], v53 offset:8
    ds_read_b64_tr_b16 v[44:45], v52 offset:512
    ds_read_b64_tr_b16 v[46:47], v53 offset:520
    ds_read_b64_tr_b16 v[48:49], v52 offset:1024
    ds_read_b64_tr_b16 v[50:51], v53 offset:1032
    s_cmp_ge_u32 s45, 5
    s_cbranch_scc1 MT_117
    s_cmp_ge_u32 s45, 3
    s_cbranch_scc1 MT_118
    s_cmp_ge_u32 s45, 2
    s_cbranch_scc1 MT_119
    s_cmp_ge_u32 s45, 1
    s_cbranch_scc1 MT_120
    s_waitcnt lgkmcnt(0)
    v_mfma_f32_16x16x32_bf16 a[0:3], v[36:39], v[40:43], a[0:3]
    v_mfma_f32_16x16x32_bf16 a[4:7], v[36:39], v[44:47], a[4:7]
    v_mfma_f32_16x16x32_bf16 a[8:11], v[36:39], v[48:51], a[8:11]
    ds_read_b64_tr_b16 v[36:37], v4 offset:3072
    ds_read_b64_tr_b16 v[38:39], v4 offset:3104
    ds_read_b64_tr_b16 v[40:41], v54 offset:256
    ds_read_b64_tr_b16 v[42:43], v55 offset:264
    ds_read_b64_tr_b16 v[44:45], v54 offset:768
    ds_read_b64_tr_b16 v[46:47], v55 offset:776
    ds_read_b64_tr_b16 v[48:49], v54 offset:1280
    ds_read_b64_tr_b16 v[50:51], v55 offset:1288
    s_waitcnt lgkmcnt(0)
    v_mfma_f32_16x16x32_bf16 a[0:3], v[36:39], v[40:43], a[0:3]
    v_mfma_f32_16x16x32_bf16 a[4:7], v[36:39], v[44:47], a[4:7]
    v_mfma_f32_16x16x32_bf16 a[8:11], v[36:39], v[48:51], a[8:11]
    s_branch MDONE_116
MT_120:
    s_waitcnt lgkmcnt(0)
    v_mfma_f32_16x16x32_bf16 a[12:15], v[36:39], v[40:43], a[12:15]
    v_mfma_f32_16x16x32_bf16 a[16:19], v[36:39], v[44:47], a[16:19]
    v_mfma_f32_16x16x32_bf16 a[20:23], v[36:39], v[48:51], a[20:23]
    ds_read_b64_tr_b16 v[36:37], v4 offset:3072
    ds_read_b64_tr_b16 v[38:39], v4 offset:3104
    ds_read_b64_tr_b16 v[40:41], v54 offset:256
    ds_read_b64_tr_b16 v[42:43], v55 offset:264
    ds_read_b64_tr_b16 v[44:45], v54 offset:768
    ds_read_b64_tr_b16 v[46:47], v55 offset:776
    ds_read_b64_tr_b16 v[48:49], v54 offset:1280
    ds_read_b64_tr_b16 v[50:51], v55 offset:1288
    s_waitcnt lgkmcnt(0)
    v_mfma_f32_16x16x32_bf16 a[12:15], v[36:39], v[40:43], a[12:15]
    v_mfma_f32_16x16x32_bf16 a[16:19], v[36:39], v[44:47], a[16:19]
    v_mfma_f32_16x16x32_bf16 a[20:23], v[36:39], v[48:51], a[20:23]
    s_branch MDONE_116
MT_119:
    s_waitcnt lgkmcnt(0)
    v_mfma_f32_16x16x32_bf16 a[24:27], v[36:39], v[40:43], a[24:27]
    v_mfma_f32_16x16x32_bf16 a[28:31], v[36:39], v[44:47], a[28:31]
    v_mfma_f32_16x16x32_bf16 a[32:35], v[36:39], v[48:51], a[32:35]
    ds_read_b64_tr_b16 v[36:37], v4 offset:3072
    ds_read_b64_tr_b16 v[38:39], v4 offset:3104
    ds_read_b64_tr_b16 v[40:41], v54 offset:256
    ds_read_b64_tr_b16 v[42:43], v55 offset:264
    ds_read_b64_tr_b16 v[44:45], v54 offset:768
    ds_read_b64_tr_b16 v[46:47], v55 offset:776
    ds_read_b64_tr_b16 v[48:49], v54 offset:1280
    ds_read_b64_tr_b16 v[50:51], v55 offset:1288
    s_waitcnt lgkmcnt(0)
    v_mfma_f32_16x16x32_bf16 a[24:27], v[36:39], v[40:43], a[24:27]
    v_mfma_f32_16x16x32_bf16 a[28:31], v[36:39], v[44:47], a[28:31]
    v_mfma_f32_16x16x32_bf16 a[32:35], v[36:39], v[48:51], a[32:35]
    s_branch MDONE_116
MT_118:
    s_cmp_ge_u32 s45, 4
    s_cbranch_scc1 MT_121
    s_waitcnt lgkmcnt(0)
    v_mfma_f32_16x16x32_bf16 a[36:39], v[36:39], v[40:43], a[36:39]
    v_mfma_f32_16x16x32_bf16 a[40:43], v[36:39], v[44:47], a[40:43]
    v_mfma_f32_16x16x32_bf16 a[44:47], v[36:39], v[48:51], a[44:47]
    ds_read_b64_tr_b16 v[36:37], v4 offset:3072
    ds_read_b64_tr_b16 v[38:39], v4 offset:3104
    ds_read_b64_tr_b16 v[40:41], v54 offset:256
    ds_read_b64_tr_b16 v[42:43], v55 offset:264
    ds_read_b64_tr_b16 v[44:45], v54 offset:768
    ds_read_b64_tr_b16 v[46:47], v55 offset:776
    ds_read_b64_tr_b16 v[48:49], v54 offset:1280
    ds_read_b64_tr_b16 v[50:51], v55 offset:1288
    s_waitcnt lgkmcnt(0)
    v_mfma_f32_16x16x32_bf16 a[36:39], v[36:39], v[40:43], a[36:39]
    v_mfma_f32_16x16x32_bf16 a[40:43], v[36:39], v[44:47], a[40:43]
    v_mfma_f32_16x16x32_bf16 a[44:47], v[36:39], v[48:51], a[44:47]
    s_branch MDONE_116
MT_121:
    s_waitcnt lgkmcnt(0)
    v_mfma_f32_16x16x32_bf16 a[48:51], v[36:39], v[40:43], a[48:51]
    v_mfma_f32_16x16x32_bf16 a[52:55], v[36:39], v[44:47], a[52:55]
    v_mfma_f32_16x16x32_bf16 a[56:59], v[36:39], v[48:51], a[56:59]
    ds_read_b64_tr_b16 v[36:37], v4 offset:3072
    ds_read_b64_tr_b16 v[38:39], v4 offset:3104
    ds_read_b64_tr_b16 v[40:41], v54 offset:256
    ds_read_b64_tr_b16 v[42:43], v55 offset:264
    ds_read_b64_tr_b16 v[44:45], v54 offset:768
    ds_read_b64_tr_b16 v[46:47], v55 offset:776
    ds_read_b64_tr_b16 v[48:49], v54 offset:1280
    ds_read_b64_tr_b16 v[50:51], v55 offset:1288
    s_waitcnt lgkmcnt(0)
    v_mfma_f32_16x16x32_bf16 a[48:51], v[36:39], v[40:43], a[48:51]
    v_mfma_f32_16x16x32_bf16 a[52:55], v[36:39], v[44:47], a[52:55]
    v_mfma_f32_16x16x32_bf16 a[56:59], v[36:39], v[48:51], a[56:59]
    s_branch MDONE_116
MT_117:
    s_cmp_ge_u32 s45, 7
    s_cbranch_scc1 MT_122
    s_cmp_ge_u32 s45, 6
    s_cbranch_scc1 MT_123
    s_waitcnt lgkmcnt(0)
    v_mfma_f32_16x16x32_bf16 a[60:63], v[36:39], v[40:43], a[60:63]
    v_mfma_f32_16x16x32_bf16 a[64:67], v[36:39], v[44:47], a[64:67]
    v_mfma_f32_16x16x32_bf16 a[68:71], v[36:39], v[48:51], a[68:71]
    ds_read_b64_tr_b16 v[36:37], v4 offset:3072
    ds_read_b64_tr_b16 v[38:39], v4 offset:3104
    ds_read_b64_tr_b16 v[40:41], v54 offset:256
    ds_read_b64_tr_b16 v[42:43], v55 offset:264
    ds_read_b64_tr_b16 v[44:45], v54 offset:768
    ds_read_b64_tr_b16 v[46:47], v55 offset:776
    ds_read_b64_tr_b16 v[48:49], v54 offset:1280
    ds_read_b64_tr_b16 v[50:51], v55 offset:1288
    s_waitcnt lgkmcnt(0)
    v_mfma_f32_16x16x32_bf16 a[60:63], v[36:39], v[40:43], a[60:63]
    v_mfma_f32_16x16x32_bf16 a[64:67], v[36:39], v[44:47], a[64:67]
    v_mfma_f32_16x16x32_bf16 a[68:71], v[36:39], v[48:51], a[68:71]
    s_branch MDONE_116
MT_123:
    s_waitcnt lgkmcnt(0)
    v_mfma_f32_16x16x32_bf16 a[72:75], v[36:39], v[40:43], a[72:75]
    v_mfma_f32_16x16x32_bf16 a[76:79], v[36:39], v[44:47], a[76:79]
    v_mfma_f32_16x16x32_bf16 a[80:83], v[36:39], v[48:51], a[80:83]
    ds_read_b64_tr_b16 v[36:37], v4 offset:3072
    ds_read_b64_tr_b16 v[38:39], v4 offset:3104
    ds_read_b64_tr_b16 v[40:41], v54 offset:256
    ds_read_b64_tr_b16 v[42:43], v55 offset:264
    ds_read_b64_tr_b16 v[44:45], v54 offset:768
    ds_read_b64_tr_b16 v[46:47], v55 offset:776
    ds_read_b64_tr_b16 v[48:49], v54 offset:1280
    ds_read_b64_tr_b16 v[50:51], v55 offset:1288
    s_waitcnt lgkmcnt(0)
    v_mfma_f32_16x16x32_bf16 a[72:75], v[36:39], v[40:43], a[72:75]
    v_mfma_f32_16x16x32_bf16 a[76:79], v[36:39], v[44:47], a[76:79]
    v_mfma_f32_16x16x32_bf16 a[80:83], v[36:39], v[48:51], a[80:83]
    s_branch MDONE_116
MT_122:
    s_cmp_ge_u32 s45, 8
    s_cbranch_scc1 MT_124
    s_waitcnt lgkmcnt(0)
    v_mfma_f32_16x16x32_bf16 a[84:87], v[36:39], v[40:43], a[84:87]
    v_mfma_f32_16x16x32_bf16 a[88:91], v[36:39], v[44:47], a[88:91]
    v_mfma_f32_16x16x32_bf16 a[92:95], v[36:39], v[48:51], a[92:95]
    ds_read_b64_tr_b16 v[36:37], v4 offset:3072
    ds_read_b64_tr_b16 v[38:39], v4 offset:3104
    ds_read_b64_tr_b16 v[40:41], v54 offset:256
    ds_read_b64_tr_b16 v[42:43], v55 offset:264
    ds_read_b64_tr_b16 v[44:45], v54 offset:768
    ds_read_b64_tr_b16 v[46:47], v55 offset:776
    ds_read_b64_tr_b16 v[48:49], v54 offset:1280
    ds_read_b64_tr_b16 v[50:51], v55 offset:1288
    s_waitcnt lgkmcnt(0)
    v_mfma_f32_16x16x32_bf16 a[84:87], v[36:39], v[40:43], a[84:87]
    v_mfma_f32_16x16x32_bf16 a[88:91], v[36:39], v[44:47], a[88:91]
    v_mfma_f32_16x16x32_bf16 a[92:95], v[36:39], v[48:51], a[92:95]
    s_branch MDONE_116
MT_124:
    s_waitcnt lgkmcnt(0)
    v_mfma_f32_16x16x32_bf16 a[96:99], v[36:39], v[40:43], a[96:99]
    v_mfma_f32_16x16x32_bf16 a[100:103], v[36:39], v[44:47], a[100:103]
    v_mfma_f32_16x16x32_bf16 a[104:107], v[36:39], v[48:51], a[104:107]
    ds_read_b64_tr_b16 v[36:37], v4 offset:3072
    ds_read_b64_tr_b16 v[38:39], v4 offset:3104
    ds_read_b64_tr_b16 v[40:41], v54 offset:256
    ds_read_b64_tr_b16 v[42:43], v55 offset:264
    ds_read_b64_tr_b16 v[44:45], v54 offset:768
    ds_read_b64_tr_b16 v[46:47], v55 offset:776
    ds_read_b64_tr_b16 v[48:49], v54 offset:1280
    ds_read_b64_tr_b16 v[50:51], v55 offset:1288
    s_waitcnt lgkmcnt(0)
    v_mfma_f32_16x16x32_bf16 a[96:99], v[36:39], v[40:43], a[96:99]
    v_mfma_f32_16x16x32_bf16 a[100:103], v[36:39], v[44:47], a[100:103]
    v_mfma_f32_16x16x32_bf16 a[104:107], v[36:39], v[48:51], a[104:107]
MDONE_116:
AFTER_111:
    s_bitset0_b32 s43, 1
    s_cmp_eq_u32 s51, -1
    s_cbranch_scc1 INVAL_112
    s_lshl_b32 s66, s51, 8
    s_and_b32 s66, s66, 0x80000000
    v_bitop3_b32 v52, v24, v25, s66 bitop3:0x7e
    v_mov_b32 v53, 64
    v_cmp_gt_i32 vcc, 0, v52
    s_cmp_lg_u64 vcc, 0
    s_cbranch_scc1 INVAL_112
    s_cmp_ge_u32 s51, 0xffc00000
    s_cbranch_scc1 WRAP_114
WRAPB_115:
    s_lshl_b64 exec, 1, s55
    ds_add_u32 v9, v53 offset:25088
    s_mov_b64 exec, -1
    s_add_u32 m0, s71, 2048
    v_and_or_b32 v52, v24, s38, v3
    v_and_or_b32 v53, v25, s38, v3
    buffer_load_dwordx4 v52, s[8:11], 0 offen lds
    s_add_u32 m0, s71, 3072
    v_mov_b32 v32, v24
    buffer_load_dwordx4 v53, s[8:11], 0 offen lds
    v_mov_b32 v33, v25
    v_mov_b32 v34, v26
    v_mov_b32 v35, v27
    s_bitset1_b32 s43, 1
    s_mov_b32 s45, s55
FIN_113:
    s_cmp_lt_u32 s37, 12
    s_cbranch_scc1 CONT_125
    s_cmp_eq_u32 s43, 0
    s_cbranch_scc1 P2_EPOCH
CONT_125:
    s_cmp_eq_u32 s60, 0
    s_cbranch_scc1 NOSLEEP_126
    s_cmp_lg_u32 s43, 0
    s_cbranch_scc1 NOSLEEP_126
    s_sleep 16
NOSLEEP_126:
    s_branch P2_LOOP
WRAP_56:
    v_mov_b32 v53, 0xffff0040
    s_branch WRAPB_57
NOOLD_52:
    s_waitcnt vmcnt(3) lgkmcnt(0)
    s_branch AFTER_53
INVAL_54:
    s_mov_b64 exec, 1
    v_mov_b32 v11, -16
    buffer_load_dword v11, v11, s[12:15], 0 offen
    buffer_load_dword v11, v11, s[12:15], 0 offen
    s_mov_b64 exec, -1
    s_branch FIN_55
WRAP_72:
    v_mov_b32 v53, 0xffff0040
    s_branch WRAPB_73
NOOLD_68:
    s_waitcnt vmcnt(3) lgkmcnt(0)
    s_branch AFTER_69
INVAL_70:
    s_mov_b64 exec, 1
    v_mov_b32 v11, -16
    buffer_load_dword v11, v11, s[12:15], 0 offen
    buffer_load_dword v11, v11, s[12:15], 0 offen
    s_mov_b64 exec, -1
    s_branch FIN_71
DRAIN_49:
    ds_read_b32 v59, v9 offset:25088
    s_mov_b64 exec, 1
    v_mov_b32 v11, -16
    buffer_load_dword v11, v11, s[12:15], 0 offen
    s_mov_b64 exec, -1
    s_waitcnt lgkmcnt(0)
    s_branch POLL_50
RETRYRD_44:
    s_cmp_lg_u32 s36, 1
    s_cbranch_scc1 SKIPI_43
    s_mov_b64 exec, s[28:29]
    ds_read_b32 v42, v54 offset:25088
    s_mov_b64 exec, s[30:31]
    ds_read_b32 v43, v55 offset:25088
    s_mov_b64 exec, -1
    s_waitcnt lgkmcnt(0)
    v_bfi_b32 v22, s73, v42, v22
    v_bfi_b32 v23, s73, v43, v23
    s_branch COMMON_45
SKIPI_43:
    s_waitcnt lgkmcnt(0)
    s_mov_b64 exec, 1
    v_mov_b32 v11, -16
    buffer_load_dword v11, v11, s[12:15], 0 offen
    s_mov_b64 exec, -1
    s_branch ISSUED_47
PEND_46:
    s_mov_b32 s36, 1
    s_add_u32 s78, s78, 1
    s_sleep 2
    s_mov_b64 exec, 1
    v_mov_b32 v11, -16
    buffer_load_dword v11, v11, s[12:15], 0 offen
    s_mov_b64 exec, -1
    s_branch ISSUED_47
WRAP_98:
    v_mov_b32 v53, 0xffff0040
    s_branch WRAPB_99
NOOLD_94:
    s_waitcnt vmcnt(3) lgkmcnt(0)
    s_branch AFTER_95
INVAL_96:
    s_mov_b64 exec, 1
    v_mov_b32 v11, -16
    buffer_load_dword v11, v11, s[12:15], 0 offen
    buffer_load_dword v11, v11, s[12:15], 0 offen
    s_mov_b64 exec, -1
    s_branch FIN_97
WRAP_114:
    v_mov_b32 v53, 0xffff0040
    s_branch WRAPB_115
NOOLD_110:
    s_waitcnt vmcnt(3) lgkmcnt(0)
    s_branch AFTER_111
INVAL_112:
    s_mov_b64 exec, 1
    v_mov_b32 v11, -16
    buffer_load_dword v11, v11, s[12:15], 0 offen
    buffer_load_dword v11, v11, s[12:15], 0 offen
    s_mov_b64 exec, -1
    s_branch FIN_113
DRAIN_91:
    ds_read_b32 v59, v9 offset:25088
    s_mov_b64 exec, 1
    v_mov_b32 v11, -16
    buffer_load_dword v11, v11, s[12:15], 0 offen
    s_mov_b64 exec, -1
    s_waitcnt lgkmcnt(0)
    s_branch POLL_92
RETRYRD_86:
    s_cmp_lg_u32 s36, 2
    s_cbranch_scc1 SKIPI_85
    s_mov_b64 exec, s[32:33]
    ds_read_b32 v42, v54 offset:25088
    s_mov_b64 exec, s[34:35]
    ds_read_b32 v43, v55 offset:25088
    s_mov_b64 exec, -1
    s_waitcnt lgkmcnt(0)
    v_bfi_b32 v22, s73, v42, v22
    v_bfi_b32 v23, s73, v43, v23
    s_branch COMMON_87
SKIPI_85:
    s_waitcnt lgkmcnt(0)
    s_mov_b64 exec, 1
    v_mov_b32 v11, -16
    buffer_load_dword v11, v11, s[12:15], 0 offen
    s_mov_b64 exec, -1
    s_branch ISSUED_89
PEND_88:
    s_mov_b32 s36, 2
    s_add_u32 s78, s78, 1
    s_sleep 2
    s_mov_b64 exec, 1
    v_mov_b32 v11, -16
    buffer_load_dword v11, v11, s[12:15], 0 offen
    s_mov_b64 exec, -1
    s_branch ISSUED_89
LSLOW_18:
    s_and_saveexec_b64 s[68:69], vcc
    v_add_u32 v55, 16, v55
LSL_20:
    v_min_u32 v57, 16, v53
    v_lshl_or_b32 v58, v57, 24, v55
    v_min_u32 v50, s65, v54
    v_lshl_add_u32 v50, v50, 2, v49
    ds_write_b32 v50, v58
    v_add_u32 v54, 1, v54
    v_add_u32 v55, 8, v55
    v_sub_u32 v53, v53, v57
    v_cmp_lt_u32 vcc, 0, v53
    s_and_b64 exec, exec, vcc
    s_cbranch_execnz LSL_20
    s_mov_b64 exec, s[68:69]
    s_branch LBACK_19
LSLOW_21:
    s_and_saveexec_b64 s[68:69], vcc
    v_add_u32 v55, 16, v55
LSL_23:
    v_min_u32 v57, 16, v53
    v_lshl_or_b32 v58, v57, 24, v55
    v_min_u32 v50, s65, v54
    v_lshl_add_u32 v50, v50, 2, v49
    ds_write_b32 v50, v58
    v_add_u32 v54, 1, v54
    v_add_u32 v55, 8, v55
    v_sub_u32 v53, v53, v57
    v_cmp_lt_u32 vcc, 0, v53
    s_and_b64 exec, exec, vcc
    s_cbranch_execnz LSL_23
    s_mov_b64 exec, s[68:69]
    s_branch LBACK_22
LSLOW_24:
    s_and_saveexec_b64 s[68:69], vcc
    v_add_u32 v55, 16, v55
LSL_26:
    v_min_u32 v57, 16, v53
    v_lshl_or_b32 v58, v57, 24, v55
    v_min_u32 v50, s65, v54
    v_lshl_add_u32 v50, v50, 2, v49
    ds_write_b32 v50, v58
    v_add_u32 v54, 1, v54
    v_add_u32 v55, 8, v55
    v_sub_u32 v53, v53, v57
    v_cmp_lt_u32 vcc, 0, v53
    s_and_b64 exec, exec, vcc
    s_cbranch_execnz LSL_26
    s_mov_b64 exec, s[68:69]
    s_branch LBACK_25
LSLOW_27:
    s_and_saveexec_b64 s[68:69], vcc
    v_add_u32 v55, 16, v55
LSL_29:
    v_min_u32 v57, 16, v53
    v_lshl_or_b32 v58, v57, 24, v55
    v_min_u32 v50, s65, v54
    v_lshl_add_u32 v50, v50, 2, v49
    ds_write_b32 v50, v58
    v_add_u32 v54, 1, v54
    v_add_u32 v55, 8, v55
    v_sub_u32 v53, v53, v57
    v_cmp_lt_u32 vcc, 0, v53
    s_and_b64 exec, exec, vcc
    s_cbranch_execnz LSL_29
    s_mov_b64 exec, s[68:69]
    s_branch LBACK_28
LSLOW_30:
    s_and_saveexec_b64 s[68:69], vcc
    v_add_u32 v55, 16, v55
LSL_32:
    v_min_u32 v57, 16, v53
    v_lshl_or_b32 v58, v57, 24, v55
    v_min_u32 v50, s65, v54
    v_lshl_add_u32 v50, v50, 2, v49
    ds_write_b32 v50, v58
    v_add_u32 v54, 1, v54
    v_add_u32 v55, 8, v55
    v_sub_u32 v53, v53, v57
    v_cmp_lt_u32 vcc, 0, v53
    s_and_b64 exec, exec, vcc
    s_cbranch_execnz LSL_32
    s_mov_b64 exec, s[68:69]
    s_branch LBACK_31
LSLOW_33:
    s_and_saveexec_b64 s[68:69], vcc
    v_add_u32 v55, 16, v55
LSL_35:
    v_min_u32 v57, 16, v53
    v_lshl_or_b32 v58, v57, 24, v55
    v_min_u32 v50, s65, v54
    v_lshl_add_u32 v50, v50, 2, v49
    ds_write_b32 v50, v58
    v_add_u32 v54, 1, v54
    v_add_u32 v55, 8, v55
    v_sub_u32 v53, v53, v57
    v_cmp_lt_u32 vcc, 0, v53
    s_and_b64 exec, exec, vcc
    s_cbranch_execnz LSL_35
    s_mov_b64 exec, s[68:69]
    s_branch LBACK_34
LSLOW_36:
    s_and_saveexec_b64 s[68:69], vcc
    v_add_u32 v55, 16, v55
LSL_38:
    v_min_u32 v57, 16, v53
    v_lshl_or_b32 v58, v57, 24, v55
    v_min_u32 v50, s65, v54
    v_lshl_add_u32 v50, v50, 2, v49
    ds_write_b32 v50, v58
    v_add_u32 v54, 1, v54
    v_add_u32 v55, 8, v55
    v_sub_u32 v53, v53, v57
    v_cmp_lt_u32 vcc, 0, v53
    s_and_b64 exec, exec, vcc
    s_cbranch_execnz LSL_38
    s_mov_b64 exec, s[68:69]
    s_branch LBACK_37
LSLOW_39:
    s_and_saveexec_b64 s[68:69], vcc
    v_add_u32 v55, 16, v55
LSL_41:
    v_min_u32 v57, 16, v53
    v_lshl_or_b32 v58, v57, 24, v55
    v_min_u32 v50, s65, v54
    v_lshl_add_u32 v50, v50, 2, v49
    ds_write_b32 v50, v58
    v_add_u32 v54, 1, v54
    v_add_u32 v55, 8, v55
    v_sub_u32 v53, v53, v57
    v_cmp_lt_u32 vcc, 0, v53
    s_and_b64 exec, exec, vcc
    s_cbranch_execnz LSL_41
    s_mov_b64 exec, s[68:69]
    s_branch LBACK_40
P2_EPOCH:
    s_add_u32 s46, s46, 5088
    s_cmp_ge_u32 s46, s47
    s_cbranch_scc1 P2_FLUSH
    s_waitcnt vmcnt(0) lgkmcnt(0)
    s_barrier
    s_setprio 0
    s_branch P2_BUILD
P2_FLUSH:
    s_load_dwordx2 s[44:45], s[0:1], 24
    s_load_dwordx2 s[46:47], s[0:1], 40
    s_load_dwordx4 s[48:51], s[0:1], 56
    s_load_dwordx4 s[52:55], s[0:1], 72
    s_waitcnt vmcnt(0)
    ds_read_b32 v59, v9 offset:25088
    v_mov_b32 v10, 0
    s_waitcnt lgkmcnt(0)
    s_mov_b64 exec, s[62:63]
    v_sub_u16_sdwa v10, v59, v59 dst_sel:DWORD dst_unused:UNUSED_PAD src0_sel:WORD_1 src1_sel:WORD_0
    s_mov_b64 exec, -1
    v_lshlrev_b32 v21, 7, v9
    v_and_b32 v36, 64, v59
    v_lshl_add_u32 v21, v36, 2, v21
    s_nop 1
    v_readlane_b32 s66, v21, 0
    v_readlane_b32 s78, v10, 0
    s_lshr_b32 s67, s66, 1
    v_add_u32 v25, s66, v0
    v_add_u32 v26, s66, v1
    v_add_u32 v27, s67, v2
    ds_read_b32 v24, v25 offset:25728
    ds_read_b32 v25, v25 offset:25856
    ds_read_b32 v26, v26 offset:25728
    ds_read_u16_d16_hi v27, v27 offset:0
    s_waitcnt lgkmcnt(0)
    s_mov_b32 s76, s78
    s_add_u32 m0, s71, 0
    v_and_or_b32 v52, v24, s38, v3
    v_and_or_b32 v53, v25, s38, v3
    s_lshl_b32 s66, s76, 2
    s_sub_i32 s67, s66, 128
    s_max_i32 s67, s67, 0
    v_cmp_gt_u32 vcc, s66, v0
    s_nop 1
    v_cndmask_b32 v52, 2.0, v52, vcc
    v_cmp_gt_u32 vcc, s67, v0
    s_nop 1
    v_cndmask_b32 v53, 2.0, v53, vcc
    buffer_load_dwordx4 v52, s[8:11], 0 offen lds
    s_add_u32 m0, s71, 1024
    v_mov_b32 v28, v24
    buffer_load_dwordx4 v53, s[8:11], 0 offen lds
    v_mov_b32 v29, v25
    v_mov_b32 v30, v26
    v_mov_b32 v31, v27
    v_readlane_b32 s66, v21, 1
    v_readlane_b32 s78, v10, 1
    s_lshr_b32 s67, s66, 1
    v_add_u32 v25, s66, v0
    v_add_u32 v26, s66, v1
    v_add_u32 v27, s67, v2
    ds_read_b32 v24, v25 offset:25728
    ds_read_b32 v25, v25 offset:25856
    ds_read_b32 v26, v26 offset:25728
    ds_read_u16_d16_hi v27, v27 offset:0
    s_waitcnt lgkmcnt(0)
    s_mov_b32 s77, s78
    s_add_u32 m0, s71, 2048
    v_and_or_b32 v52, v24, s38, v3
    v_and_or_b32 v53, v25, s38, v3
    s_lshl_b32 s66, s77, 2
    s_sub_i32 s67, s66, 128
    s_max_i32 s67, s67, 0
    v_cmp_gt_u32 vcc, s66, v0
    s_nop 1
    v_cndmask_b32 v52, 2.0, v52, vcc
    v_cmp_gt_u32 vcc, s67, v0
    s_nop 1
    v_cndmask_b32 v53, 2.0, v53, vcc
    buffer_load_dwordx4 v52, s[8:11], 0 offen lds
    s_add_u32 m0, s71, 3072
    v_mov_b32 v32, v24
    buffer_load_dwordx4 v53, s[8:11], 0 offen lds
    v_mov_b32 v33, v25
    v_mov_b32 v34, v26
    v_mov_b32 v35, v27
    v_readlane_b32 s66, v21, 2
    v_readlane_b32 s78, v10, 2
    s_lshr_b32 s67, s66, 1
    v_add_u32 v25, s66, v0
    v_add_u32 v26, s66, v1
    v_add_u32 v27, s67, v2
    ds_read_b32 v24, v25 offset:25728
    ds_read_b32 v25, v25 offset:25856
    ds_read_b32 v26, v26 offset:25728
    ds_read_u16_d16_hi v27, v27 offset:0
    s_cmp_eq_u32 s76, 0
    s_cbranch_scc1 FSK_127
    v_mul_f32 v40, 0.15915494, v31
    v_mul_f32 v42, 0x40400000, v31
    v_fract_f32 v40, v40
    v_cvt_pk_bf16_f32 v42, 0, v42
    v_cos_f32 v40, v40
    v_mul_f32 v42, 0.15915494, v42
    v_and_b32_sdwa v38, 12, v28 dst_sel:WORD_1 dst_unused:UNUSED_PAD src0_sel:DWORD src1_sel:BYTE_0
    s_lshl_b32 s66, s76, 2
    s_sub_i32 s66, s66, 0
    s_max_i32 s66, s66, 0
    v_cmp_le_u32 vcc, s66, v0
    v_or_b32 v36, 0x100000, v38
    s_nop 0
    v_cndmask_b32 v38, v38, v36, vcc
    v_fract_f32 v42, v42
    v_lshlrev_b32 v43, 4, v30
    v_xor_b32_dpp v52, v38, v6 quad_perm:[0,0,0,0] row_mask:0xf bank_mask:0xf
    v_xor_b32_dpp v53, v38, v6 quad_perm:[2,2,2,2] row_mask:0xf bank_mask:0xf
    v_and_b32_sdwa v38, 12, v29 dst_sel:WORD_1 dst_unused:UNUSED_PAD src0_sel:DWORD src1_sel:BYTE_0
    s_lshl_b32 s66, s76, 2
    s_sub_i32 s66, s66, 128
    s_max_i32 s66, s66, 0
    v_cmp_le_u32 vcc, s66, v0
    v_or_b32 v36, 0x100000, v38
    s_nop 0
    v_cndmask_b32 v38, v38, v36, vcc
    v_cos_f32 v42, v42
    v_add_f32 v41, v40, v40
    v_xor_b32_dpp v54, v38, v6 quad_perm:[0,0,0,0] row_mask:0xf bank_mask:0xf
    v_xor_b32_dpp v55, v38, v6 quad_perm:[2,2,2,2] row_mask:0xf bank_mask:0xf
    v_cvt_pk_bf16_f32 v16, v40, 0
    v_fma_f32 v41, v41, v40, -1.0
    v_lshlrev_b64 v[44:45], v43, v[16:17]
    v_cvt_pk_bf16_f32 v16, v41, 0
    ds_write_b64 v7, v[44:45]
    v_lshlrev_b64 v[46:47], v43, v[16:17]
    v_cvt_pk_bf16_f32 v16, v42, 0
    ds_write_b64 v7, v[46:47] offset:512
    v_lshlrev_b64 v[48:49], v43, v[16:17]
    v_add_u32 v52, v52, v5
    v_add_u32 v53, v53, v5
    v_add_u32 v54, v54, v5
    v_add_u32 v55, v55, v5
    ds_write_b64 v7, v[48:49] offset:1024
    s_waitcnt vmcnt(2)
    ds_read_b64_tr_b16 v[36:37], v4 offset:0
    ds_read_b64_tr_b16 v[38:39], v4 offset:32
    ds_read_b64_tr_b16 v[40:41], v52 offset:0
    ds_read_b64_tr_b16 v[42:43], v53 offset:8
    ds_read_b64_tr_b16 v[44:45], v52 offset:512
    ds_read_b64_tr_b16 v[46:47], v53 offset:520
    ds_read_b64_tr_b16 v[48:49], v52 offset:1024
    ds_read_b64_tr_b16 v[50:51], v53 offset:1032
    s_waitcnt lgkmcnt(0)
    v_mfma_f32_16x16x32_bf16 a[0:3], v[36:39], v[40:43], a[0:3]
    v_mfma_f32_16x16x32_bf16 a[4:7], v[36:39], v[44:47], a[4:7]
    v_mfma_f32_16x16x32_bf16 a[8:11], v[36:39], v[48:51], a[8:11]
    s_cmp_le_u32 s76, 32
    s_cbranch_scc1 MDONE_129
    ds_read_b64_tr_b16 v[36:37], v4 offset:1024
    ds_read_b64_tr_b16 v[38:39], v4 offset:1056
    ds_read_b64_tr_b16 v[40:41], v54 offset:256
    ds_read_b64_tr_b16 v[42:43], v55 offset:264
    ds_read_b64_tr_b16 v[44:45], v54 offset:768
    ds_read_b64_tr_b16 v[46:47], v55 offset:776
    ds_read_b64_tr_b16 v[48:49], v54 offset:1280
    ds_read_b64_tr_b16 v[50:51], v55 offset:1288
    s_waitcnt lgkmcnt(0)
    v_mfma_f32_16x16x32_bf16 a[0:3], v[36:39], v[40:43], a[0:3]
    v_mfma_f32_16x16x32_bf16 a[4:7], v[36:39], v[44:47], a[4:7]
    v_mfma_f32_16x16x32_bf16 a[8:11], v[36:39], v[48:51], a[8:11]
MDONE_129:
FSK_127:
    s_waitcnt lgkmcnt(0)
    s_mov_b32 s76, s78
    s_add_u32 m0, s71, 0
    v_and_or_b32 v52, v24, s38, v3
    v_and_or_b32 v53, v25, s38, v3
    s_lshl_b32 s66, s76, 2
    s_sub_i32 s67, s66, 128
    s_max_i32 s67, s67, 0
    v_cmp_gt_u32 vcc, s66, v0
    s_nop 1
    v_cndmask_b32 v52, 2.0, v52, vcc
    v_cmp_gt_u32 vcc, s67, v0
    s_nop 1
    v_cndmask_b32 v53, 2.0, v53, vcc
    buffer_load_dwordx4 v52, s[8:11], 0 offen lds
    s_add_u32 m0, s71, 1024
    v_mov_b32 v28, v24
    buffer_load_dwordx4 v53, s[8:11], 0 offen lds
    v_mov_b32 v29, v25
    v_mov_b32 v30, v26
    v_mov_b32 v31, v27
    v_readlane_b32 s66, v21, 3
    v_readlane_b32 s78, v10, 3
    s_lshr_b32 s67, s66, 1
    v_add_u32 v25, s66, v0
    v_add_u32 v26, s66, v1
    v_add_u32 v27, s67, v2
    ds_read_b32 v24, v25 offset:25728
    ds_read_b32 v25, v25 offset:25856
    ds_read_b32 v26, v26 offset:25728
    ds_read_u16_d16_hi v27, v27 offset:0
    s_cmp_eq_u32 s77, 0
    s_cbranch_scc1 FSK_130
    v_mul_f32 v40, 0.15915494, v35
    v_mul_f32 v42, 0x40400000, v35
    v_fract_f32 v40, v40
    v_cvt_pk_bf16_f32 v42, 0, v42
    v_cos_f32 v40, v40
    v_mul_f32 v42, 0.15915494, v42
    v_and_b32_sdwa v38, 12, v32 dst_sel:WORD_1 dst_unused:UNUSED_PAD src0_sel:DWORD src1_sel:BYTE_0
    s_lshl_b32 s66, s77, 2
    s_sub_i32 s66, s66, 0
    s_max_i32 s66, s66, 0
    v_cmp_le_u32 vcc, s66, v0
    v_or_b32 v36, 0x100000, v38
    s_nop 0
    v_cndmask_b32 v38, v38, v36, vcc
    v_fract_f32 v42, v42
    v_lshlrev_b32 v43, 4, v34
    v_xor_b32_dpp v52, v38, v6 quad_perm:[0,0,0,0] row_mask:0xf bank_mask:0xf
    v_xor_b32_dpp v53, v38, v6 quad_perm:[2,2,2,2] row_mask:0xf bank_mask:0xf
    v_and_b32_sdwa v38, 12, v33 dst_sel:WORD_1 dst_unused:UNUSED_PAD src0_sel:DWORD src1_sel:BYTE_0
    s_lshl_b32 s66, s77, 2
    s_sub_i32 s66, s66, 128
    s_max_i32 s66, s66, 0
    v_cmp_le_u32 vcc, s66, v0
    v_or_b32 v36, 0x100000, v38
    s_nop 0
    v_cndmask_b32 v38, v38, v36, vcc
    v_cos_f32 v42, v42
    v_add_f32 v41, v40, v40
    v_xor_b32_dpp v54, v38, v6 quad_perm:[0,0,0,0] row_mask:0xf bank_mask:0xf
    v_xor_b32_dpp v55, v38, v6 quad_perm:[2,2,2,2] row_mask:0xf bank_mask:0xf
    v_cvt_pk_bf16_f32 v16, v40, 0
    v_fma_f32 v41, v41, v40, -1.0
    v_lshlrev_b64 v[44:45], v43, v[16:17]
    v_cvt_pk_bf16_f32 v16, v41, 0
    ds_write_b64 v7, v[44:45]
    v_lshlrev_b64 v[46:47], v43, v[16:17]
    v_cvt_pk_bf16_f32 v16, v42, 0
    ds_write_b64 v7, v[46:47] offset:512
    v_lshlrev_b64 v[48:49], v43, v[16:17]
    v_add_u32 v52, v52, v5
    v_add_u32 v53, v53, v5
    v_add_u32 v54, v54, v5
    v_add_u32 v55, v55, v5
    ds_write_b64 v7, v[48:49] offset:1024
    s_waitcnt vmcnt(2)
    ds_read_b64_tr_b16 v[36:37], v4 offset:2048
    ds_read_b64_tr_b16 v[38:39], v4 offset:2080
    ds_read_b64_tr_b16 v[40:41], v52 offset:0
    ds_read_b64_tr_b16 v[42:43], v53 offset:8
    ds_read_b64_tr_b16 v[44:45], v52 offset:512
    ds_read_b64_tr_b16 v[46:47], v53 offset:520
    ds_read_b64_tr_b16 v[48:49], v52 offset:1024
    ds_read_b64_tr_b16 v[50:51], v53 offset:1032
    s_waitcnt lgkmcnt(0)
    v_mfma_f32_16x16x32_bf16 a[12:15], v[36:39], v[40:43], a[12:15]
    v_mfma_f32_16x16x32_bf16 a[16:19], v[36:39], v[44:47], a[16:19]
    v_mfma_f32_16x16x32_bf16 a[20:23], v[36:39], v[48:51], a[20:23]
    s_cmp_le_u32 s77, 32
    s_cbranch_scc1 MDONE_132
    ds_read_b64_tr_b16 v[36:37], v4 offset:3072
    ds_read_b64_tr_b16 v[38:39], v4 offset:3104
    ds_read_b64_tr_b16 v[40:41], v54 offset:256
    ds_read_b64_tr_b16 v[42:43], v55 offset:264
    ds_read_b64_tr_b16 v[44:45], v54 offset:768
    ds_read_b64_tr_b16 v[46:47], v55 offset:776
    ds_read_b64_tr_b16 v[48:49], v54 offset:1280
    ds_read_b64_tr_b16 v[50:51], v55 offset:1288
    s_waitcnt lgkmcnt(0)
    v_mfma_f32_16x16x32_bf16 a[12:15], v[36:39], v[40:43], a[12:15]
    v_mfma_f32_16x16x32_bf16 a[16:19], v[36:39], v[44:47], a[16:19]
    v_mfma_f32_16x16x32_bf16 a[20:23], v[36:39], v[48:51], a[20:23]
MDONE_132:
FSK_130:
    s_waitcnt lgkmcnt(0)
    s_mov_b32 s77, s78
    s_add_u32 m0, s71, 2048
    v_and_or_b32 v52, v24, s38, v3
    v_and_or_b32 v53, v25, s38, v3
    s_lshl_b32 s66, s77, 2
    s_sub_i32 s67, s66, 128
    s_max_i32 s67, s67, 0
    v_cmp_gt_u32 vcc, s66, v0
    s_nop 1
    v_cndmask_b32 v52, 2.0, v52, vcc
    v_cmp_gt_u32 vcc, s67, v0
    s_nop 1
    v_cndmask_b32 v53, 2.0, v53, vcc
    buffer_load_dwordx4 v52, s[8:11], 0 offen lds
    s_add_u32 m0, s71, 3072
    v_mov_b32 v32, v24
    buffer_load_dwordx4 v53, s[8:11], 0 offen lds
    v_mov_b32 v33, v25
    v_mov_b32 v34, v26
    v_mov_b32 v35, v27
    v_readlane_b32 s66, v21, 4
    v_readlane_b32 s78, v10, 4
    s_lshr_b32 s67, s66, 1
    v_add_u32 v25, s66, v0
    v_add_u32 v26, s66, v1
    v_add_u32 v27, s67, v2
    ds_read_b32 v24, v25 offset:25728
    ds_read_b32 v25, v25 offset:25856
    ds_read_b32 v26, v26 offset:25728
    ds_read_u16_d16_hi v27, v27 offset:0
    s_cmp_eq_u32 s76, 0
    s_cbranch_scc1 FSK_133
    v_mul_f32 v40, 0.15915494, v31
    v_mul_f32 v42, 0x40400000, v31
    v_fract_f32 v40, v40
    v_cvt_pk_bf16_f32 v42, 0, v42
    v_cos_f32 v40, v40
    v_mul_f32 v42, 0.15915494, v42
    v_and_b32_sdwa v38, 12, v28 dst_sel:WORD_1 dst_unused:UNUSED_PAD src0_sel:DWORD src1_sel:BYTE_0
    s_lshl_b32 s66, s76, 2
    s_sub_i32 s66, s66, 0
    s_max_i32 s66, s66, 0
    v_cmp_le_u32 vcc, s66, v0
    v_or_b32 v36, 0x100000, v38
    s_nop 0
    v_cndmask_b32 v38, v38, v36, vcc
    v_fract_f32 v42, v42
    v_lshlrev_b32 v43, 4, v30
    v_xor_b32_dpp v52, v38, v6 quad_perm:[0,0,0,0] row_mask:0xf bank_mask:0xf
    v_xor_b32_dpp v53, v38, v6 quad_perm:[2,2,2,2] row_mask:0xf bank_mask:0xf
    v_and_b32_sdwa v38, 12, v29 dst_sel:WORD_1 dst_unused:UNUSED_PAD src0_sel:DWORD src1_sel:BYTE_0
    s_lshl_b32 s66, s76, 2
    s_sub_i32 s66, s66, 128
    s_max_i32 s66, s66, 0
    v_cmp_le_u32 vcc, s66, v0
    v_or_b32 v36, 0x100000, v38
    s_nop 0
    v_cndmask_b32 v38, v38, v36, vcc
    v_cos_f32 v42, v42
    v_add_f32 v41, v40, v40
    v_xor_b32_dpp v54, v38, v6 quad_perm:[0,0,0,0] row_mask:0xf bank_mask:0xf
    v_xor_b32_dpp v55, v38, v6 quad_perm:[2,2,2,2] row_mask:0xf bank_mask:0xf
    v_cvt_pk_bf16_f32 v16, v40, 0
    v_fma_f32 v41, v41, v40, -1.0
    v_lshlrev_b64 v[44:45], v43, v[16:17]
    v_cvt_pk_bf16_f32 v16, v41, 0
    ds_write_b64 v7, v[44:45]
    v_lshlrev_b64 v[46:47], v43, v[16:17]
    v_cvt_pk_bf16_f32 v16, v42, 0
    ds_write_b64 v7, v[46:47] offset:512
    v_lshlrev_b64 v[48:49], v43, v[16:17]
    v_add_u32 v52, v52, v5
    v_add_u32 v53, v53, v5
    v_add_u32 v54, v54, v5
    v_add_u32 v55, v55, v5
    ds_write_b64 v7, v[48:49] offset:1024
    s_waitcnt vmcnt(2)
    ds_read_b64_tr_b16 v[36:37], v4 offset:0
    ds_read_b64_tr_b16 v[38:39], v4 offset:32
    ds_read_b64_tr_b16 v[40:41], v52 offset:0
    ds_read_b64_tr_b16 v[42:43], v53 offset:8
    ds_read_b64_tr_b16 v[44:45], v52 offset:512
    ds_read_b64_tr_b16 v[46:47], v53 offset:520
    ds_read_b64_tr_b16 v[48:49], v52 offset:1024
    ds_read_b64_tr_b16 v[50:51], v53 offset:1032
    s_waitcnt lgkmcnt(0)
    v_mfma_f32_16x16x32_bf16 a[24:27], v[36:39], v[40:43], a[24:27]
    v_mfma_f32_16x16x32_bf16 a[28:31], v[36:39], v[44:47], a[28:31]
    v_mfma_f32_16x16x32_bf16 a[32:35], v[36:39], v[48:51], a[32:35]
    s_cmp_le_u32 s76, 32
    s_cbranch_scc1 MDONE_135
    ds_read_b64_tr_b16 v[36:37], v4 offset:1024
    ds_read_b64_tr_b16 v[38:39], v4 offset:1056
    ds_read_b64_tr_b16 v[40:41], v54 offset:256
    ds_read_b64_tr_b16 v[42:43], v55 offset:264
    ds_read_b64_tr_b16 v[44:45], v54 offset:768
    ds_read_b64_tr_b16 v[46:47], v55 offset:776
    ds_read_b64_tr_b16 v[48:49], v54 offset:1280
    ds_read_b64_tr_b16 v[50:51], v55 offset:1288
    s_waitcnt lgkmcnt(0)
    v_mfma_f32_16x16x32_bf16 a[24:27], v[36:39], v[40:43], a[24:27]
    v_mfma_f32_16x16x32_bf16 a[28:31], v[36:39], v[44:47], a[28:31]
    v_mfma_f32_16x16x32_bf16 a[32:35], v[36:39], v[48:51], a[32:35]
MDONE_135:
FSK_133:
    s_waitcnt lgkmcnt(0)
    s_mov_b32 s76, s78
    s_add_u32 m0, s71, 0
    v_and_or_b32 v52, v24, s38, v3
    v_and_or_b32 v53, v25, s38, v3
    s_lshl_b32 s66, s76, 2
    s_sub_i32 s67, s66, 128
    s_max_i32 s67, s67, 0
    v_cmp_gt_u32 vcc, s66, v0
    s_nop 1
    v_cndmask_b32 v52, 2.0, v52, vcc
    v_cmp_gt_u32 vcc, s67, v0
    s_nop 1
    v_cndmask_b32 v53, 2.0, v53, vcc
    buffer_load_dwordx4 v52, s[8:11], 0 offen lds
    s_add_u32 m0, s71, 1024
    v_mov_b32 v28, v24
    buffer_load_dwordx4 v53, s[8:11], 0 offen lds
    v_mov_b32 v29, v25
    v_mov_b32 v30, v26
    v_mov_b32 v31, v27
    v_readlane_b32 s66, v21, 5
    v_readlane_b32 s78, v10, 5
    s_lshr_b32 s67, s66, 1
    v_add_u32 v25, s66, v0
    v_add_u32 v26, s66, v1
    v_add_u32 v27, s67, v2
    ds_read_b32 v24, v25 offset:25728
    ds_read_b32 v25, v25 offset:25856
    ds_read_b32 v26, v26 offset:25728
    ds_read_u16_d16_hi v27, v27 offset:0
    s_cmp_eq_u32 s77, 0
    s_cbranch_scc1 FSK_136
    v_mul_f32 v40, 0.15915494, v35
    v_mul_f32 v42, 0x40400000, v35
    v_fract_f32 v40, v40
    v_cvt_pk_bf16_f32 v42, 0, v42
    v_cos_f32 v40, v40
    v_mul_f32 v42, 0.15915494, v42
    v_and_b32_sdwa v38, 12, v32 dst_sel:WORD_1 dst_unused:UNUSED_PAD src0_sel:DWORD src1_sel:BYTE_0
    s_lshl_b32 s66, s77, 2
    s_sub_i32 s66, s66, 0
    s_max_i32 s66, s66, 0
    v_cmp_le_u32 vcc, s66, v0
    v_or_b32 v36, 0x100000, v38
    s_nop 0
    v_cndmask_b32 v38, v38, v36, vcc
    v_fract_f32 v42, v42
    v_lshlrev_b32 v43, 4, v34
    v_xor_b32_dpp v52, v38, v6 quad_perm:[0,0,0,0] row_mask:0xf bank_mask:0xf
    v_xor_b32_dpp v53, v38, v6 quad_perm:[2,2,2,2] row_mask:0xf bank_mask:0xf
    v_and_b32_sdwa v38, 12, v33 dst_sel:WORD_1 dst_unused:UNUSED_PAD src0_sel:DWORD src1_sel:BYTE_0
    s_lshl_b32 s66, s77, 2
    s_sub_i32 s66, s66, 128
    s_max_i32 s66, s66, 0
    v_cmp_le_u32 vcc, s66, v0
    v_or_b32 v36, 0x100000, v38
    s_nop 0
    v_cndmask_b32 v38, v38, v36, vcc
    v_cos_f32 v42, v42
    v_add_f32 v41, v40, v40
    v_xor_b32_dpp v54, v38, v6 quad_perm:[0,0,0,0] row_mask:0xf bank_mask:0xf
    v_xor_b32_dpp v55, v38, v6 quad_perm:[2,2,2,2] row_mask:0xf bank_mask:0xf
    v_cvt_pk_bf16_f32 v16, v40, 0
    v_fma_f32 v41, v41, v40, -1.0
    v_lshlrev_b64 v[44:45], v43, v[16:17]
    v_cvt_pk_bf16_f32 v16, v41, 0
    ds_write_b64 v7, v[44:45]
    v_lshlrev_b64 v[46:47], v43, v[16:17]
    v_cvt_pk_bf16_f32 v16, v42, 0
    ds_write_b64 v7, v[46:47] offset:512
    v_lshlrev_b64 v[48:49], v43, v[16:17]
    v_add_u32 v52, v52, v5
    v_add_u32 v53, v53, v5
    v_add_u32 v54, v54, v5
    v_add_u32 v55, v55, v5
    ds_write_b64 v7, v[48:49] offset:1024
    s_waitcnt vmcnt(2)
    ds_read_b64_tr_b16 v[36:37], v4 offset:2048
    ds_read_b64_tr_b16 v[38:39], v4 offset:2080
    ds_read_b64_tr_b16 v[40:41], v52 offset:0
    ds_read_b64_tr_b16 v[42:43], v53 offset:8
    ds_read_b64_tr_b16 v[44:45], v52 offset:512
    ds_read_b64_tr_b16 v[46:47], v53 offset:520
    ds_read_b64_tr_b16 v[48:49], v52 offset:1024
    ds_read_b64_tr_b16 v[50:51], v53 offset:1032
    s_waitcnt lgkmcnt(0)
    v_mfma_f32_16x16x32_bf16 a[36:39], v[36:39], v[40:43], a[36:39]
    v_mfma_f32_16x16x32_bf16 a[40:43], v[36:39], v[44:47], a[40:43]
    v_mfma_f32_16x16x32_bf16 a[44:47], v[36:39], v[48:51], a[44:47]
    s_cmp_le_u32 s77, 32
    s_cbranch_scc1 MDONE_138
    ds_read_b64_tr_b16 v[36:37], v4 offset:3072
    ds_read_b64_tr_b16 v[38:39], v4 offset:3104
    ds_read_b64_tr_b16 v[40:41], v54 offset:256
    ds_read_b64_tr_b16 v[42:43], v55 offset:264
    ds_read_b64_tr_b16 v[44:45], v54 offset:768
    ds_read_b64_tr_b16 v[46:47], v55 offset:776
    ds_read_b64_tr_b16 v[48:49], v54 offset:1280
    ds_read_b64_tr_b16 v[50:51], v55 offset:1288
    s_waitcnt lgkmcnt(0)
    v_mfma_f32_16x16x32_bf16 a[36:39], v[36:39], v[40:43], a[36:39]
    v_mfma_f32_16x16x32_bf16 a[40:43], v[36:39], v[44:47], a[40:43]
    v_mfma_f32_16x16x32_bf16 a[44:47], v[36:39], v[48:51], a[44:47]
MDONE_138:
FSK_136:
    s_waitcnt lgkmcnt(0)
    s_mov_b32 s77, s78
    s_add_u32 m0, s71, 2048
    v_and_or_b32 v52, v24, s38, v3
    v_and_or_b32 v53, v25, s38, v3
    s_lshl_b32 s66, s77, 2
    s_sub_i32 s67, s66, 128
    s_max_i32 s67, s67, 0
    v_cmp_gt_u32 vcc, s66, v0
    s_nop 1
    v_cndmask_b32 v52, 2.0, v52, vcc
    v_cmp_gt_u32 vcc, s67, v0
    s_nop 1
    v_cndmask_b32 v53, 2.0, v53, vcc
    buffer_load_dwordx4 v52, s[8:11], 0 offen lds
    s_add_u32 m0, s71, 3072
    v_mov_b32 v32, v24
    buffer_load_dwordx4 v53, s[8:11], 0 offen lds
    v_mov_b32 v33, v25
    v_mov_b32 v34, v26
    v_mov_b32 v35, v27
    v_readlane_b32 s66, v21, 6
    v_readlane_b32 s78, v10, 6
    s_lshr_b32 s67, s66, 1
    v_add_u32 v25, s66, v0
    v_add_u32 v26, s66, v1
    v_add_u32 v27, s67, v2
    ds_read_b32 v24, v25 offset:25728
    ds_read_b32 v25, v25 offset:25856
    ds_read_b32 v26, v26 offset:25728
    ds_read_u16_d16_hi v27, v27 offset:0
    s_cmp_eq_u32 s76, 0
    s_cbranch_scc1 FSK_139
    v_mul_f32 v40, 0.15915494, v31
    v_mul_f32 v42, 0x40400000, v31
    v_fract_f32 v40, v40
    v_cvt_pk_bf16_f32 v42, 0, v42
    v_cos_f32 v40, v40
    v_mul_f32 v42, 0.15915494, v42
    v_and_b32_sdwa v38, 12, v28 dst_sel:WORD_1 dst_unused:UNUSED_PAD src0_sel:DWORD src1_sel:BYTE_0
    s_lshl_b32 s66, s76, 2
    s_sub_i32 s66, s66, 0
    s_max_i32 s66, s66, 0
    v_cmp_le_u32 vcc, s66, v0
    v_or_b32 v36, 0x100000, v38
    s_nop 0
    v_cndmask_b32 v38, v38, v36, vcc
    v_fract_f32 v42, v42
    v_lshlrev_b32 v43, 4, v30
    v_xor_b32_dpp v52, v38, v6 quad_perm:[0,0,0,0] row_mask:0xf bank_mask:0xf
    v_xor_b32_dpp v53, v38, v6 quad_perm:[2,2,2,2] row_mask:0xf bank_mask:0xf
    v_and_b32_sdwa v38, 12, v29 dst_sel:WORD_1 dst_unused:UNUSED_PAD src0_sel:DWORD src1_sel:BYTE_0
    s_lshl_b32 s66, s76, 2
    s_sub_i32 s66, s66, 128
    s_max_i32 s66, s66, 0
    v_cmp_le_u32 vcc, s66, v0
    v_or_b32 v36, 0x100000, v38
    s_nop 0
    v_cndmask_b32 v38, v38, v36, vcc
    v_cos_f32 v42, v42
    v_add_f32 v41, v40, v40
    v_xor_b32_dpp v54, v38, v6 quad_perm:[0,0,0,0] row_mask:0xf bank_mask:0xf
    v_xor_b32_dpp v55, v38, v6 quad_perm:[2,2,2,2] row_mask:0xf bank_mask:0xf
    v_cvt_pk_bf16_f32 v16, v40, 0
    v_fma_f32 v41, v41, v40, -1.0
    v_lshlrev_b64 v[44:45], v43, v[16:17]
    v_cvt_pk_bf16_f32 v16, v41, 0
    ds_write_b64 v7, v[44:45]
    v_lshlrev_b64 v[46:47], v43, v[16:17]
    v_cvt_pk_bf16_f32 v16, v42, 0
    ds_write_b64 v7, v[46:47] offset:512
    v_lshlrev_b64 v[48:49], v43, v[16:17]
    v_add_u32 v52, v52, v5
    v_add_u32 v53, v53, v5
    v_add_u32 v54, v54, v5
    v_add_u32 v55, v55, v5
    ds_write_b64 v7, v[48:49] offset:1024
    s_waitcnt vmcnt(2)
    ds_read_b64_tr_b16 v[36:37], v4 offset:0
    ds_read_b64_tr_b16 v[38:39], v4 offset:32
    ds_read_b64_tr_b16 v[40:41], v52 offset:0
    ds_read_b64_tr_b16 v[42:43], v53 offset:8
    ds_read_b64_tr_b16 v[44:45], v52 offset:512
    ds_read_b64_tr_b16 v[46:47], v53 offset:520
    ds_read_b64_tr_b16 v[48:49], v52 offset:1024
    ds_read_b64_tr_b16 v[50:51], v53 offset:1032
    s_waitcnt lgkmcnt(0)
    v_mfma_f32_16x16x32_bf16 a[48:51], v[36:39], v[40:43], a[48:51]
    v_mfma_f32_16x16x32_bf16 a[52:55], v[36:39], v[44:47], a[52:55]
    v_mfma_f32_16x16x32_bf16 a[56:59], v[36:39], v[48:51], a[56:59]
    s_cmp_le_u32 s76, 32
    s_cbranch_scc1 MDONE_141
    ds_read_b64_tr_b16 v[36:37], v4 offset:1024
    ds_read_b64_tr_b16 v[38:39], v4 offset:1056
    ds_read_b64_tr_b16 v[40:41], v54 offset:256
    ds_read_b64_tr_b16 v[42:43], v55 offset:264
    ds_read_b64_tr_b16 v[44:45], v54 offset:768
    ds_read_b64_tr_b16 v[46:47], v55 offset:776
    ds_read_b64_tr_b16 v[48:49], v54 offset:1280
    ds_read_b64_tr_b16 v[50:51], v55 offset:1288
    s_waitcnt lgkmcnt(0)
    v_mfma_f32_16x16x32_bf16 a[48:51], v[36:39], v[40:43], a[48:51]
    v_mfma_f32_16x16x32_bf16 a[52:55], v[36:39], v[44:47], a[52:55]
    v_mfma_f32_16x16x32_bf16 a[56:59], v[36:39], v[48:51], a[56:59]
MDONE_141:
FSK_139:
    s_waitcnt lgkmcnt(0)
    s_mov_b32 s76, s78
    s_add_u32 m0, s71, 0
    v_and_or_b32 v52, v24, s38, v3
    v_and_or_b32 v53, v25, s38, v3
    s_lshl_b32 s66, s76, 2
    s_sub_i32 s67, s66, 128
    s_max_i32 s67, s67, 0
    v_cmp_gt_u32 vcc, s66, v0
    s_nop 1
    v_cndmask_b32 v52, 2.0, v52, vcc
    v_cmp_gt_u32 vcc, s67, v0
    s_nop 1
    v_cndmask_b32 v53, 2.0, v53, vcc
    buffer_load_dwordx4 v52, s[8:11], 0 offen lds
    s_add_u32 m0, s71, 1024
    v_mov_b32 v28, v24
    buffer_load_dwordx4 v53, s[8:11], 0 offen lds
    v_mov_b32 v29, v25
    v_mov_b32 v30, v26
    v_mov_b32 v31, v27
    v_readlane_b32 s66, v21, 7
    v_readlane_b32 s78, v10, 7
    s_lshr_b32 s67, s66, 1
    v_add_u32 v25, s66, v0
    v_add_u32 v26, s66, v1
    v_add_u32 v27, s67, v2
    ds_read_b32 v24, v25 offset:25728
    ds_read_b32 v25, v25 offset:25856
    ds_read_b32 v26, v26 offset:25728
    ds_read_u16_d16_hi v27, v27 offset:0
    s_cmp_eq_u32 s77, 0
    s_cbranch_scc1 FSK_142
    v_mul_f32 v40, 0.15915494, v35
    v_mul_f32 v42, 0x40400000, v35
    v_fract_f32 v40, v40
    v_cvt_pk_bf16_f32 v42, 0, v42
    v_cos_f32 v40, v40
    v_mul_f32 v42, 0.15915494, v42
    v_and_b32_sdwa v38, 12, v32 dst_sel:WORD_1 dst_unused:UNUSED_PAD src0_sel:DWORD src1_sel:BYTE_0
    s_lshl_b32 s66, s77, 2
    s_sub_i32 s66, s66, 0
    s_max_i32 s66, s66, 0
    v_cmp_le_u32 vcc, s66, v0
    v_or_b32 v36, 0x100000, v38
    s_nop 0
    v_cndmask_b32 v38, v38, v36, vcc
    v_fract_f32 v42, v42
    v_lshlrev_b32 v43, 4, v34
    v_xor_b32_dpp v52, v38, v6 quad_perm:[0,0,0,0] row_mask:0xf bank_mask:0xf
    v_xor_b32_dpp v53, v38, v6 quad_perm:[2,2,2,2] row_mask:0xf bank_mask:0xf
    v_and_b32_sdwa v38, 12, v33 dst_sel:WORD_1 dst_unused:UNUSED_PAD src0_sel:DWORD src1_sel:BYTE_0
    s_lshl_b32 s66, s77, 2
    s_sub_i32 s66, s66, 128
    s_max_i32 s66, s66, 0
    v_cmp_le_u32 vcc, s66, v0
    v_or_b32 v36, 0x100000, v38
    s_nop 0
    v_cndmask_b32 v38, v38, v36, vcc
    v_cos_f32 v42, v42
    v_add_f32 v41, v40, v40
    v_xor_b32_dpp v54, v38, v6 quad_perm:[0,0,0,0] row_mask:0xf bank_mask:0xf
    v_xor_b32_dpp v55, v38, v6 quad_perm:[2,2,2,2] row_mask:0xf bank_mask:0xf
    v_cvt_pk_bf16_f32 v16, v40, 0
    v_fma_f32 v41, v41, v40, -1.0
    v_lshlrev_b64 v[44:45], v43, v[16:17]
    v_cvt_pk_bf16_f32 v16, v41, 0
    ds_write_b64 v7, v[44:45]
    v_lshlrev_b64 v[46:47], v43, v[16:17]
    v_cvt_pk_bf16_f32 v16, v42, 0
    ds_write_b64 v7, v[46:47] offset:512
    v_lshlrev_b64 v[48:49], v43, v[16:17]
    v_add_u32 v52, v52, v5
    v_add_u32 v53, v53, v5
    v_add_u32 v54, v54, v5
    v_add_u32 v55, v55, v5
    ds_write_b64 v7, v[48:49] offset:1024
    s_waitcnt vmcnt(2)
    ds_read_b64_tr_b16 v[36:37], v4 offset:2048
    ds_read_b64_tr_b16 v[38:39], v4 offset:2080
    ds_read_b64_tr_b16 v[40:41], v52 offset:0
    ds_read_b64_tr_b16 v[42:43], v53 offset:8
    ds_read_b64_tr_b16 v[44:45], v52 offset:512
    ds_read_b64_tr_b16 v[46:47], v53 offset:520
    ds_read_b64_tr_b16 v[48:49], v52 offset:1024
    ds_read_b64_tr_b16 v[50:51], v53 offset:1032
    s_waitcnt lgkmcnt(0)
    v_mfma_f32_16x16x32_bf16 a[60:63], v[36:39], v[40:43], a[60:63]
    v_mfma_f32_16x16x32_bf16 a[64:67], v[36:39], v[44:47], a[64:67]
    v_mfma_f32_16x16x32_bf16 a[68:71], v[36:39], v[48:51], a[68:71]
    s_cmp_le_u32 s77, 32
    s_cbranch_scc1 MDONE_144
    ds_read_b64_tr_b16 v[36:37], v4 offset:3072
    ds_read_b64_tr_b16 v[38:39], v4 offset:3104
    ds_read_b64_tr_b16 v[40:41], v54 offset:256
    ds_read_b64_tr_b16 v[42:43], v55 offset:264
    ds_read_b64_tr_b16 v[44:45], v54 offset:768
    ds_read_b64_tr_b16 v[46:47], v55 offset:776
    ds_read_b64_tr_b16 v[48:49], v54 offset:1280
    ds_read_b64_tr_b16 v[50:51], v55 offset:1288
    s_waitcnt lgkmcnt(0)
    v_mfma_f32_16x16x32_bf16 a[60:63], v[36:39], v[40:43], a[60:63]
    v_mfma_f32_16x16x32_bf16 a[64:67], v[36:39], v[44:47], a[64:67]
    v_mfma_f32_16x16x32_bf16 a[68:71], v[36:39], v[48:51], a[68:71]
MDONE_144:
FSK_142:
    s_waitcnt lgkmcnt(0)
    s_mov_b32 s77, s78
    s_add_u32 m0, s71, 2048
    v_and_or_b32 v52, v24, s38, v3
    v_and_or_b32 v53, v25, s38, v3
    s_lshl_b32 s66, s77, 2
    s_sub_i32 s67, s66, 128
    s_max_i32 s67, s67, 0
    v_cmp_gt_u32 vcc, s66, v0
    s_nop 1
    v_cndmask_b32 v52, 2.0, v52, vcc
    v_cmp_gt_u32 vcc, s67, v0
    s_nop 1
    v_cndmask_b32 v53, 2.0, v53, vcc
    buffer_load_dwordx4 v52, s[8:11], 0 offen lds
    s_add_u32 m0, s71, 3072
    v_mov_b32 v32, v24
    buffer_load_dwordx4 v53, s[8:11], 0 offen lds
    v_mov_b32 v33, v25
    v_mov_b32 v34, v26
    v_mov_b32 v35, v27
    v_readlane_b32 s66, v21, 8
    v_readlane_b32 s78, v10, 8
    s_lshr_b32 s67, s66, 1
    v_add_u32 v25, s66, v0
    v_add_u32 v26, s66, v1
    v_add_u32 v27, s67, v2
    ds_read_b32 v24, v25 offset:25728
    ds_read_b32 v25, v25 offset:25856
    ds_read_b32 v26, v26 offset:25728
    ds_read_u16_d16_hi v27, v27 offset:0
    s_cmp_eq_u32 s76, 0
    s_cbranch_scc1 FSK_145
    v_mul_f32 v40, 0.15915494, v31
    v_mul_f32 v42, 0x40400000, v31
    v_fract_f32 v40, v40
    v_cvt_pk_bf16_f32 v42, 0, v42
    v_cos_f32 v40, v40
    v_mul_f32 v42, 0.15915494, v42
    v_and_b32_sdwa v38, 12, v28 dst_sel:WORD_1 dst_unused:UNUSED_PAD src0_sel:DWORD src1_sel:BYTE_0
    s_lshl_b32 s66, s76, 2
    s_sub_i32 s66, s66, 0
    s_max_i32 s66, s66, 0
    v_cmp_le_u32 vcc, s66, v0
    v_or_b32 v36, 0x100000, v38
    s_nop 0
    v_cndmask_b32 v38, v38, v36, vcc
    v_fract_f32 v42, v42
    v_lshlrev_b32 v43, 4, v30
    v_xor_b32_dpp v52, v38, v6 quad_perm:[0,0,0,0] row_mask:0xf bank_mask:0xf
    v_xor_b32_dpp v53, v38, v6 quad_perm:[2,2,2,2] row_mask:0xf bank_mask:0xf
    v_and_b32_sdwa v38, 12, v29 dst_sel:WORD_1 dst_unused:UNUSED_PAD src0_sel:DWORD src1_sel:BYTE_0
    s_lshl_b32 s66, s76, 2
    s_sub_i32 s66, s66, 128
    s_max_i32 s66, s66, 0
    v_cmp_le_u32 vcc, s66, v0
    v_or_b32 v36, 0x100000, v38
    s_nop 0
    v_cndmask_b32 v38, v38, v36, vcc
    v_cos_f32 v42, v42
    v_add_f32 v41, v40, v40
    v_xor_b32_dpp v54, v38, v6 quad_perm:[0,0,0,0] row_mask:0xf bank_mask:0xf
    v_xor_b32_dpp v55, v38, v6 quad_perm:[2,2,2,2] row_mask:0xf bank_mask:0xf
    v_cvt_pk_bf16_f32 v16, v40, 0
    v_fma_f32 v41, v41, v40, -1.0
    v_lshlrev_b64 v[44:45], v43, v[16:17]
    v_cvt_pk_bf16_f32 v16, v41, 0
    ds_write_b64 v7, v[44:45]
    v_lshlrev_b64 v[46:47], v43, v[16:17]
    v_cvt_pk_bf16_f32 v16, v42, 0
    ds_write_b64 v7, v[46:47] offset:512
    v_lshlrev_b64 v[48:49], v43, v[16:17]
    v_add_u32 v52, v52, v5
    v_add_u32 v53, v53, v5
    v_add_u32 v54, v54, v5
    v_add_u32 v55, v55, v5
    ds_write_b64 v7, v[48:49] offset:1024
    s_waitcnt vmcnt(2)
    ds_read_b64_tr_b16 v[36:37], v4 offset:0
    ds_read_b64_tr_b16 v[38:39], v4 offset:32
    ds_read_b64_tr_b16 v[40:41], v52 offset:0
    ds_read_b64_tr_b16 v[42:43], v53 offset:8
    ds_read_b64_tr_b16 v[44:45], v52 offset:512
    ds_read_b64_tr_b16 v[46:47], v53 offset:520
    ds_read_b64_tr_b16 v[48:49], v52 offset:1024
    ds_read_b64_tr_b16 v[50:51], v53 offset:1032
    s_waitcnt lgkmcnt(0)
    v_mfma_f32_16x16x32_bf16 a[72:75], v[36:39], v[40:43], a[72:75]
    v_mfma_f32_16x16x32_bf16 a[76:79], v[36:39], v[44:47], a[76:79]
    v_mfma_f32_16x16x32_bf16 a[80:83], v[36:39], v[48:51], a[80:83]
    s_cmp_le_u32 s76, 32
    s_cbranch_scc1 MDONE_147
    ds_read_b64_tr_b16 v[36:37], v4 offset:1024
    ds_read_b64_tr_b16 v[38:39], v4 offset:1056
    ds_read_b64_tr_b16 v[40:41], v54 offset:256
    ds_read_b64_tr_b16 v[42:43], v55 offset:264
    ds_read_b64_tr_b16 v[44:45], v54 offset:768
    ds_read_b64_tr_b16 v[46:47], v55 offset:776
    ds_read_b64_tr_b16 v[48:49], v54 offset:1280
    ds_read_b64_tr_b16 v[50:51], v55 offset:1288
    s_waitcnt lgkmcnt(0)
    v_mfma_f32_16x16x32_bf16 a[72:75], v[36:39], v[40:43], a[72:75]
    v_mfma_f32_16x16x32_bf16 a[76:79], v[36:39], v[44:47], a[76:79]
    v_mfma_f32_16x16x32_bf16 a[80:83], v[36:39], v[48:51], a[80:83]
MDONE_147:
FSK_145:
    s_waitcnt lgkmcnt(0)
    s_mov_b32 s76, s78
    s_add_u32 m0, s71, 0
    v_and_or_b32 v52, v24, s38, v3
    v_and_or_b32 v53, v25, s38, v3
    s_lshl_b32 s66, s76, 2
    s_sub_i32 s67, s66, 128
    s_max_i32 s67, s67, 0
    v_cmp_gt_u32 vcc, s66, v0
    s_nop 1
    v_cndmask_b32 v52, 2.0, v52, vcc
    v_cmp_gt_u32 vcc, s67, v0
    s_nop 1
    v_cndmask_b32 v53, 2.0, v53, vcc
    buffer_load_dwordx4 v52, s[8:11], 0 offen lds
    s_add_u32 m0, s71, 1024
    v_mov_b32 v28, v24
    buffer_load_dwordx4 v53, s[8:11], 0 offen lds
    v_mov_b32 v29, v25
    v_mov_b32 v30, v26
    v_mov_b32 v31, v27
    s_cmp_eq_u32 s77, 0
    s_cbranch_scc1 FSK_148
    v_mul_f32 v40, 0.15915494, v35
    v_mul_f32 v42, 0x40400000, v35
    v_fract_f32 v40, v40
    v_cvt_pk_bf16_f32 v42, 0, v42
    v_cos_f32 v40, v40
    v_mul_f32 v42, 0.15915494, v42
    v_and_b32_sdwa v38, 12, v32 dst_sel:WORD_1 dst_unused:UNUSED_PAD src0_sel:DWORD src1_sel:BYTE_0
    s_lshl_b32 s66, s77, 2
    s_sub_i32 s66, s66, 0
    s_max_i32 s66, s66, 0
    v_cmp_le_u32 vcc, s66, v0
    v_or_b32 v36, 0x100000, v38
    s_nop 0
    v_cndmask_b32 v38, v38, v36, vcc
    v_fract_f32 v42, v42
    v_lshlrev_b32 v43, 4, v34
    v_xor_b32_dpp v52, v38, v6 quad_perm:[0,0,0,0] row_mask:0xf bank_mask:0xf
    v_xor_b32_dpp v53, v38, v6 quad_perm:[2,2,2,2] row_mask:0xf bank_mask:0xf
    v_and_b32_sdwa v38, 12, v33 dst_sel:WORD_1 dst_unused:UNUSED_PAD src0_sel:DWORD src1_sel:BYTE_0
    s_lshl_b32 s66, s77, 2
    s_sub_i32 s66, s66, 128
    s_max_i32 s66, s66, 0
    v_cmp_le_u32 vcc, s66, v0
    v_or_b32 v36, 0x100000, v38
    s_nop 0
    v_cndmask_b32 v38, v38, v36, vcc
    v_cos_f32 v42, v42
    v_add_f32 v41, v40, v40
    v_xor_b32_dpp v54, v38, v6 quad_perm:[0,0,0,0] row_mask:0xf bank_mask:0xf
    v_xor_b32_dpp v55, v38, v6 quad_perm:[2,2,2,2] row_mask:0xf bank_mask:0xf
    v_cvt_pk_bf16_f32 v16, v40, 0
    v_fma_f32 v41, v41, v40, -1.0
    v_lshlrev_b64 v[44:45], v43, v[16:17]
    v_cvt_pk_bf16_f32 v16, v41, 0
    ds_write_b64 v7, v[44:45]
    v_lshlrev_b64 v[46:47], v43, v[16:17]
    v_cvt_pk_bf16_f32 v16, v42, 0
    ds_write_b64 v7, v[46:47] offset:512
    v_lshlrev_b64 v[48:49], v43, v[16:17]
    v_add_u32 v52, v52, v5
    v_add_u32 v53, v53, v5
    v_add_u32 v54, v54, v5
    v_add_u32 v55, v55, v5
    ds_write_b64 v7, v[48:49] offset:1024
    s_waitcnt vmcnt(2)
    ds_read_b64_tr_b16 v[36:37], v4 offset:2048
    ds_read_b64_tr_b16 v[38:39], v4 offset:2080
    ds_read_b64_tr_b16 v[40:41], v52 offset:0
    ds_read_b64_tr_b16 v[42:43], v53 offset:8
    ds_read_b64_tr_b16 v[44:45], v52 offset:512
    ds_read_b64_tr_b16 v[46:47], v53 offset:520
    ds_read_b64_tr_b16 v[48:49], v52 offset:1024
    ds_read_b64_tr_b16 v[50:51], v53 offset:1032
    s_waitcnt lgkmcnt(0)
    v_mfma_f32_16x16x32_bf16 a[84:87], v[36:39], v[40:43], a[84:87]
    v_mfma_f32_16x16x32_bf16 a[88:91], v[36:39], v[44:47], a[88:91]
    v_mfma_f32_16x16x32_bf16 a[92:95], v[36:39], v[48:51], a[92:95]
    s_cmp_le_u32 s77, 32
    s_cbranch_scc1 MDONE_150
    ds_read_b64_tr_b16 v[36:37], v4 offset:3072
    ds_read_b64_tr_b16 v[38:39], v4 offset:3104
    ds_read_b64_tr_b16 v[40:41], v54 offset:256
    ds_read_b64_tr_b16 v[42:43], v55 offset:264
    ds_read_b64_tr_b16 v[44:45], v54 offset:768
    ds_read_b64_tr_b16 v[46:47], v55 offset:776
    ds_read_b64_tr_b16 v[48:49], v54 offset:1280
    ds_read_b64_tr_b16 v[50:51], v55 offset:1288
    s_waitcnt lgkmcnt(0)
    v_mfma_f32_16x16x32_bf16 a[84:87], v[36:39], v[40:43], a[84:87]
    v_mfma_f32_16x16x32_bf16 a[88:91], v[36:39], v[44:47], a[88:91]
    v_mfma_f32_16x16x32_bf16 a[92:95], v[36:39], v[48:51], a[92:95]
MDONE_150:
FSK_148:
    s_cmp_eq_u32 s76, 0
    s_cbranch_scc1 FSK_151
    v_mul_f32 v40, 0.15915494, v31
    v_mul_f32 v42, 0x40400000, v31
    v_fract_f32 v40, v40
    v_cvt_pk_bf16_f32 v42, 0, v42
    v_cos_f32 v40, v40
    v_mul_f32 v42, 0.15915494, v42
    v_and_b32_sdwa v38, 12, v28 dst_sel:WORD_1 dst_unused:UNUSED_PAD src0_sel:DWORD src1_sel:BYTE_0
    s_lshl_b32 s66, s76, 2
    s_sub_i32 s66, s66, 0
    s_max_i32 s66, s66, 0
    v_cmp_le_u32 vcc, s66, v0
    v_or_b32 v36, 0x100000, v38
    s_nop 0
    v_cndmask_b32 v38, v38, v36, vcc
    v_fract_f32 v42, v42
    v_lshlrev_b32 v43, 4, v30
    v_xor_b32_dpp v52, v38, v6 quad_perm:[0,0,0,0] row_mask:0xf bank_mask:0xf
    v_xor_b32_dpp v53, v38, v6 quad_perm:[2,2,2,2] row_mask:0xf bank_mask:0xf
    v_and_b32_sdwa v38, 12, v29 dst_sel:WORD_1 dst_unused:UNUSED_PAD src0_sel:DWORD src1_sel:BYTE_0
    s_lshl_b32 s66, s76, 2
    s_sub_i32 s66, s66, 128
    s_max_i32 s66, s66, 0
    v_cmp_le_u32 vcc, s66, v0
    v_or_b32 v36, 0x100000, v38
    s_nop 0
    v_cndmask_b32 v38, v38, v36, vcc
    v_cos_f32 v42, v42
    v_add_f32 v41, v40, v40
    v_xor_b32_dpp v54, v38, v6 quad_perm:[0,0,0,0] row_mask:0xf bank_mask:0xf
    v_xor_b32_dpp v55, v38, v6 quad_perm:[2,2,2,2] row_mask:0xf bank_mask:0xf
    v_cvt_pk_bf16_f32 v16, v40, 0
    v_fma_f32 v41, v41, v40, -1.0
    v_lshlrev_b64 v[44:45], v43, v[16:17]
    v_cvt_pk_bf16_f32 v16, v41, 0
    ds_write_b64 v7, v[44:45]
    v_lshlrev_b64 v[46:47], v43, v[16:17]
    v_cvt_pk_bf16_f32 v16, v42, 0
    ds_write_b64 v7, v[46:47] offset:512
    v_lshlrev_b64 v[48:49], v43, v[16:17]
    v_add_u32 v52, v52, v5
    v_add_u32 v53, v53, v5
    v_add_u32 v54, v54, v5
    v_add_u32 v55, v55, v5
    ds_write_b64 v7, v[48:49] offset:1024
    s_waitcnt vmcnt(0)
    ds_read_b64_tr_b16 v[36:37], v4 offset:0
    ds_read_b64_tr_b16 v[38:39], v4 offset:32
    ds_read_b64_tr_b16 v[40:41], v52 offset:0
    ds_read_b64_tr_b16 v[42:43], v53 offset:8
    ds_read_b64_tr_b16 v[44:45], v52 offset:512
    ds_read_b64_tr_b16 v[46:47], v53 offset:520
    ds_read_b64_tr_b16 v[48:49], v52 offset:1024
    ds_read_b64_tr_b16 v[50:51], v53 offset:1032
    s_waitcnt lgkmcnt(0)
    v_mfma_f32_16x16x32_bf16 a[96:99], v[36:39], v[40:43], a[96:99]
    v_mfma_f32_16x16x32_bf16 a[100:103], v[36:39], v[44:47], a[100:103]
    v_mfma_f32_16x16x32_bf16 a[104:107], v[36:39], v[48:51], a[104:107]
    s_cmp_le_u32 s76, 32
    s_cbranch_scc1 MDONE_153
    ds_read_b64_tr_b16 v[36:37], v4 offset:1024
    ds_read_b64_tr_b16 v[38:39], v4 offset:1056
    ds_read_b64_tr_b16 v[40:41], v54 offset:256
    ds_read_b64_tr_b16 v[42:43], v55 offset:264
    ds_read_b64_tr_b16 v[44:45], v54 offset:768
    ds_read_b64_tr_b16 v[46:47], v55 offset:776
    ds_read_b64_tr_b16 v[48:49], v54 offset:1280
    ds_read_b64_tr_b16 v[50:51], v55 offset:1288
    s_waitcnt lgkmcnt(0)
    v_mfma_f32_16x16x32_bf16 a[96:99], v[36:39], v[40:43], a[96:99]
    v_mfma_f32_16x16x32_bf16 a[100:103], v[36:39], v[44:47], a[100:103]
    v_mfma_f32_16x16x32_bf16 a[104:107], v[36:39], v[48:51], a[104:107]
MDONE_153:
FSK_151:
P2_EPI:
    s_mov_b64 exec, -1
    s_waitcnt vmcnt(0) lgkmcnt(0)
    v_mbcnt_lo_u32_b32 v26, -1, 0
    v_mbcnt_hi_u32_b32 v26, -1, v26
    v_lshrrev_b32 v27, 4, v26
    v_and_b32 v28, 15, v26
    v_mov_b32 v14, v28
    v_lshlrev_b32 v15, 3, v27
    s_lshl_b32 s60, s3, 4
    s_add_u32 s61, s60, s42
    s_add_u32 s60, s60, 1536
    v_add_u32 v33, s60, v14
    v_cmp_gt_u32 vcc, 1563, v33
    s_mov_b64 s[56:57], vcc
    v_add_u32 v14, s61, v14
    v_lshl_add_u32 v15, v14, 5, v15
    v_lshlrev_b32 v14, 1, v14
    v_mov_b32 v32, v15
    buffer_load_dwordx2 v[36:37], v32, s[8:11], 0 offen
    v_add_u32 v33, 6144, v15
    buffer_load_dwordx2 v[38:39], v33, s[8:11], 0 offen
    v_add_u32 v32, 12288, v15
    buffer_load_dwordx2 v[40:41], v32, s[8:11], 0 offen
    v_add_u32 v33, 18432, v15
    buffer_load_dwordx2 v[42:43], v33, s[8:11], 0 offen
    v_add_u32 v32, 24576, v15
    buffer_load_dwordx2 v[44:45], v32, s[8:11], 0 offen
    v_add_u32 v33, 30720, v15
    buffer_load_dwordx2 v[46:47], v33, s[8:11], 0 offen
    s_waitcnt lgkmcnt(0)
    s_mov_b32 s16, s44
    s_and_b32 s17, s45, 0xffff
    s_mov_b32 s18, 800000
    s_mov_b32 s19, 0x20000
    v_mov_b32 v34, v14
    buffer_load_ushort v54, v34, s[16:19], 0 offen
    v_add_u32 v35, 384, v14
    buffer_load_ushort v55, v35, s[16:19], 0 offen
    v_add_u32 v34, 768, v14
    buffer_load_ushort v56, v34, s[16:19], 0 offen
    v_add_u32 v35, 1152, v14
    buffer_load_ushort v57, v35, s[16:19], 0 offen
    v_add_u32 v34, 1536, v14
    buffer_load_ushort v58, v34, s[16:19], 0 offen
    v_add_u32 v35, 1920, v14
    buffer_load_ushort v59, v35, s[16:19], 0 offen
    v_lshlrev_b32 v29, 7, v27
    v_lshl_add_u32 v29, v28, 1, v29
    s_mov_b32 s16, s52
    s_and_b32 s17, s53, 0xffff
    s_mov_b32 s18, 512
    s_mov_b32 s19, 0x20000
    buffer_load_ushort v16, v29, s[16:19], 0 offen offset:0
    buffer_load_ushort v17, v29, s[16:19], 0 offen offset:32
    buffer_load_ushort v18, v29, s[16:19], 0 offen offset:64
    buffer_load_ushort v19, v29, s[16:19], 0 offen offset:96
    s_mov_b32 s16, s54
    s_and_b32 s17, s55, 0xffff
    s_mov_b32 s18, 512
    s_mov_b32 s19, 0x20000
    buffer_load_ushort v20, v29, s[16:19], 0 offen offset:0
    buffer_load_ushort v21, v29, s[16:19], 0 offen offset:32
    buffer_load_ushort v22, v29, s[16:19], 0 offen offset:64
    buffer_load_ushort v23, v29, s[16:19], 0 offen offset:96
    v_mul_u32_u24 v30, 192, v27
    v_lshl_add_u32 v30, v28, 1, v30
    s_mov_b32 s16, s50
    s_and_b32 s17, s51, 0xffff
    s_mov_b32 s18, 768
    s_mov_b32 s19, 0x20000
    buffer_load_ushort v48, v30, s[16:19], 0 offen offset:0
    buffer_load_ushort v49, v30, s[16:19], 0 offen offset:96
    buffer_load_ushort v50, v30, s[16:19], 0 offen offset:32
    buffer_load_ushort v51, v30, s[16:19], 0 offen offset:128
    buffer_load_ushort v52, v30, s[16:19], 0 offen offset:64
    buffer_load_ushort v53, v30, s[16:19], 0 offen offset:160
    v_lshlrev_b32 v31, 6, v27
    v_lshl_add_u32 v31, v28, 1, v31
    s_mov_b32 s16, s48
    s_and_b32 s17, s49, 0xffff
    s_mov_b32 s18, 256
    s_mov_b32 s19, 0x20000
    buffer_load_ushort v24, v31, s[16:19], 0 offen offset:0
    buffer_load_ushort v25, v31, s[16:19], 0 offen offset:32
    v_lshlrev_b32 v26, 2, v27
    s_mov_b32 s16, s46
    s_and_b32 s17, s47, 0xffff
    s_mov_b32 s18, 16
    s_mov_b32 s19, 0x20000
    buffer_load_ushort v32, v26, s[16:19], 0 offen offset:0
    buffer_load_ushort v33, v26, s[16:19], 0 offen offset:2
    s_waitcnt vmcnt(0)
    v_lshl_or_b32 v0, v17, 16, v16
    v_lshl_or_b32 v1, v19, 16, v18
    v_lshl_or_b32 v2, v21, 16, v20
    v_lshl_or_b32 v3, v23, 16, v22
    v_lshl_or_b32 v4, v49, 16, v48
    v_mov_b32 v5, 0
    v_lshl_or_b32 v6, v51, 16, v50
    v_mov_b32 v7, 0
    v_lshl_or_b32 v8, v53, 16, v52
    v_mov_b32 v9, 0
    v_lshl_or_b32 v10, v25, 16, v24
    v_mov_b32 v11, 0
    v_lshlrev_b32 v12, 16, v32
    v_lshlrev_b32 v13, 16, v33
    v_mov_b32 v17, 0
    s_mov_b32 s58, 0xc1200000
    s_mov_b32 s59, 0xc1200000
    s_mov_b32 s62, 0x3fb8aa3b
    s_mov_b32 s63, 0x3fb8aa3b
    s_mov_b32 s16, s44
    s_and_b32 s17, s45, 0xffff
    s_mov_b32 s18, 800000
    s_mov_b32 s19, 0x20000
    v_add_u32 v32, 36864, v15
    buffer_load_dwordx2 v[48:49], v32, s[8:11], 0 offen
    v_add_u32 v33, 43008, v15
    buffer_load_dwordx2 v[50:51], v33, s[8:11], 0 offen
    v_add_u32 v32, 49152, v15
    v_cndmask_b32_e64 v32, -16, v32, s[56:57]
    buffer_load_dwordx2 v[52:53], v32, s[8:11], 0 offen
    v_lshlrev_b32 v34, 16, v54
    v_pk_add_f32 v[32:33], v[34:35], v[12:13] op_sel_hi:[0,1] neg_lo:[0,1] neg_hi:[0,1]
    v_cvt_pk_bf16_f32 v34, v32, v33
    v_lshlrev_b32 v32, 16, v34
    v_and_b32 v33, 0xffff0000, v34
    v_pk_mul_f32 v[32:33], v[32:33], v[32:33]
    v_cvt_pk_bf16_f32 v34, v32, v33
    v_lshlrev_b32 v32, 16, v34
    v_and_b32 v33, 0xffff0000, v34
    v_pk_mul_f32 v[32:33], v[32:33], s[58:59]
    v_cvt_pk_bf16_f32 v34, v32, v33
    v_lshlrev_b32 v32, 16, v34
    v_and_b32 v33, 0xffff0000, v34
    v_pk_mul_f32 v[32:33], v[32:33], s[62:63]
    v_exp_f32 v32, v32
    v_exp_f32 v33, v33
    s_nop 0
    v_cvt_pk_bf16_f32 v16, v32, v33
    v_add_u32 v33, 2304, v14
    buffer_load_ushort v54, v33, s[16:19], 0 offen
    v_accvgpr_read_b32 v32, a0
    v_accvgpr_read_b32 v33, a1
    v_accvgpr_read_b32 v34, a2
    v_accvgpr_read_b32 v35, a3
    v_cvt_pk_bf16_f32 v30, v32, v33
    v_cvt_pk_bf16_f32 v31, v34, v35
    s_nop 1
    v_mfma_f32_16x16x16_bf16 v[18:21], v[4:5], v[16:17], 0
    v_mfma_f32_16x16x16_bf16 v[22:25], v[0:1], v[30:31], 0
    s_nop 7
    s_nop 1
    v_pk_mul_f32 v[26:27], v[18:19], v[22:23]
    v_pk_mul_f32 v[28:29], v[20:21], v[24:25]
    v_accvgpr_read_b32 v32, a4
    v_accvgpr_read_b32 v33, a5
    v_accvgpr_read_b32 v34, a6
    v_accvgpr_read_b32 v35, a7
    v_cvt_pk_bf16_f32 v30, v32, v33
    v_cvt_pk_bf16_f32 v31, v34, v35
    s_nop 1
    v_mfma_f32_16x16x16_bf16 v[18:21], v[6:7], v[16:17], 0
    v_mfma_f32_16x16x16_bf16 v[22:25], v[0:1], v[30:31], 0
    s_nop 7
    s_nop 1
    v_pk_fma_f32 v[26:27], v[18:19], v[22:23], v[26:27]
    v_pk_fma_f32 v[28:29], v[20:21], v[24:25], v[28:29]
    v_accvgpr_read_b32 v32, a8
    v_accvgpr_read_b32 v33, a9
    v_accvgpr_read_b32 v34, a10
    v_accvgpr_read_b32 v35, a11
    v_cvt_pk_bf16_f32 v30, v32, v33
    v_cvt_pk_bf16_f32 v31, v34, v35
    s_nop 1
    v_mfma_f32_16x16x16_bf16 v[18:21], v[8:9], v[16:17], 0
    v_mfma_f32_16x16x16_bf16 v[22:25], v[0:1], v[30:31], 0
    s_nop 7
    s_nop 1
    v_pk_fma_f32 v[26:27], v[18:19], v[22:23], v[26:27]
    v_pk_fma_f32 v[28:29], v[20:21], v[24:25], v[28:29]
    v_cvt_pk_bf16_f32 v30, v26, v27
    v_cvt_pk_bf16_f32 v31, v28, v29
    s_nop 1
    v_mfma_f32_16x16x16_bf16 v[18:21], v[2:3], v[30:31], 0
    v_mfma_f32_16x16x16_bf16 v[22:25], v[10:11], v[16:17], 0
    v_mov_b32 v26, v15
    v_lshlrev_b32 v32, 16, v36
    v_and_b32 v33, 0xffff0000, v36
    v_lshlrev_b32 v34, 16, v37
    v_and_b32 v35, 0xffff0000, v37
    s_nop 3
    v_pk_fma_f32 v[32:33], v[18:19], v[22:23], v[32:33]
    v_pk_fma_f32 v[34:35], v[20:21], v[24:25], v[34:35]
    v_cvt_pk_bf16_f32 v30, v32, v33
    v_cvt_pk_bf16_f32 v31, v34, v35
    buffer_store_dwordx2 v[30:31], v26, s[20:23], 0 offen nt
ESKIP_154:
    v_lshlrev_b32 v34, 16, v55
    v_pk_add_f32 v[32:33], v[34:35], v[12:13] op_sel_hi:[0,1] neg_lo:[0,1] neg_hi:[0,1]
    v_cvt_pk_bf16_f32 v34, v32, v33
    v_lshlrev_b32 v32, 16, v34
    v_and_b32 v33, 0xffff0000, v34
    v_pk_mul_f32 v[32:33], v[32:33], v[32:33]
    v_cvt_pk_bf16_f32 v34, v32, v33
    v_lshlrev_b32 v32, 16, v34
    v_and_b32 v33, 0xffff0000, v34
    v_pk_mul_f32 v[32:33], v[32:33], s[58:59]
    v_cvt_pk_bf16_f32 v34, v32, v33
    v_lshlrev_b32 v32, 16, v34
    v_and_b32 v33, 0xffff0000, v34
    v_pk_mul_f32 v[32:33], v[32:33], s[62:63]
    v_exp_f32 v32, v32
    v_exp_f32 v33, v33
    s_nop 0
    v_cvt_pk_bf16_f32 v16, v32, v33
    v_add_u32 v33, 2688, v14
    buffer_load_ushort v55, v33, s[16:19], 0 offen
    v_accvgpr_read_b32 v32, a12
    v_accvgpr_read_b32 v33, a13
    v_accvgpr_read_b32 v34, a14
    v_accvgpr_read_b32 v35, a15
    v_cvt_pk_bf16_f32 v30, v32, v33
    v_cvt_pk_bf16_f32 v31, v34, v35
    s_nop 1
    v_mfma_f32_16x16x16_bf16 v[18:21], v[4:5], v[16:17], 0
    v_mfma_f32_16x16x16_bf16 v[22:25], v[0:1], v[30:31], 0
    s_nop 7
    s_nop 1
    v_pk_mul_f32 v[26:27], v[18:19], v[22:23]
    v_pk_mul_f32 v[28:29], v[20:21], v[24:25]
    v_accvgpr_read_b32 v32, a16
    v_accvgpr_read_b32 v33, a17
    v_accvgpr_read_b32 v34, a18
    v_accvgpr_read_b32 v35, a19
    v_cvt_pk_bf16_f32 v30, v32, v33
    v_cvt_pk_bf16_f32 v31, v34, v35
    s_nop 1
    v_mfma_f32_16x16x16_bf16 v[18:21], v[6:7], v[16:17], 0
    v_mfma_f32_16x16x16_bf16 v[22:25], v[0:1], v[30:31], 0
    s_nop 7
    s_nop 1
    v_pk_fma_f32 v[26:27], v[18:19], v[22:23], v[26:27]
    v_pk_fma_f32 v[28:29], v[20:21], v[24:25], v[28:29]
    v_accvgpr_read_b32 v32, a20
    v_accvgpr_read_b32 v33, a21
    v_accvgpr_read_b32 v34, a22
    v_accvgpr_read_b32 v35, a23
    v_cvt_pk_bf16_f32 v30, v32, v33
    v_cvt_pk_bf16_f32 v31, v34, v35
    s_nop 1
    v_mfma_f32_16x16x16_bf16 v[18:21], v[8:9], v[16:17], 0
    v_mfma_f32_16x16x16_bf16 v[22:25], v[0:1], v[30:31], 0
    s_nop 7
    s_nop 1
    v_pk_fma_f32 v[26:27], v[18:19], v[22:23], v[26:27]
    v_pk_fma_f32 v[28:29], v[20:21], v[24:25], v[28:29]
    v_cvt_pk_bf16_f32 v30, v26, v27
    v_cvt_pk_bf16_f32 v31, v28, v29
    s_nop 1
    v_mfma_f32_16x16x16_bf16 v[18:21], v[2:3], v[30:31], 0
    v_mfma_f32_16x16x16_bf16 v[22:25], v[10:11], v[16:17], 0
    v_add_u32 v26, 6144, v15
    v_lshlrev_b32 v32, 16, v38
    v_and_b32 v33, 0xffff0000, v38
    v_lshlrev_b32 v34, 16, v39
    v_and_b32 v35, 0xffff0000, v39
    s_nop 3
    v_pk_fma_f32 v[32:33], v[18:19], v[22:23], v[32:33]
    v_pk_fma_f32 v[34:35], v[20:21], v[24:25], v[34:35]
    v_cvt_pk_bf16_f32 v30, v32, v33
    v_cvt_pk_bf16_f32 v31, v34, v35
    buffer_store_dwordx2 v[30:31], v26, s[20:23], 0 offen nt
ESKIP_155:
    v_lshlrev_b32 v34, 16, v56
    v_pk_add_f32 v[32:33], v[34:35], v[12:13] op_sel_hi:[0,1] neg_lo:[0,1] neg_hi:[0,1]
    v_cvt_pk_bf16_f32 v34, v32, v33
    v_lshlrev_b32 v32, 16, v34
    v_and_b32 v33, 0xffff0000, v34
    v_pk_mul_f32 v[32:33], v[32:33], v[32:33]
    v_cvt_pk_bf16_f32 v34, v32, v33
    v_lshlrev_b32 v32, 16, v34
    v_and_b32 v33, 0xffff0000, v34
    v_pk_mul_f32 v[32:33], v[32:33], s[58:59]
    v_cvt_pk_bf16_f32 v34, v32, v33
    v_lshlrev_b32 v32, 16, v34
    v_and_b32 v33, 0xffff0000, v34
    v_pk_mul_f32 v[32:33], v[32:33], s[62:63]
    v_exp_f32 v32, v32
    v_exp_f32 v33, v33
    s_nop 0
    v_cvt_pk_bf16_f32 v16, v32, v33
    v_add_u32 v33, 3072, v14
    buffer_load_ushort v56, v33, s[16:19], 0 offen
    v_accvgpr_read_b32 v32, a24
    v_accvgpr_read_b32 v33, a25
    v_accvgpr_read_b32 v34, a26
    v_accvgpr_read_b32 v35, a27
    v_cvt_pk_bf16_f32 v30, v32, v33
    v_cvt_pk_bf16_f32 v31, v34, v35
    s_nop 1
    v_mfma_f32_16x16x16_bf16 v[18:21], v[4:5], v[16:17], 0
    v_mfma_f32_16x16x16_bf16 v[22:25], v[0:1], v[30:31], 0
    s_nop 7
    s_nop 1
    v_pk_mul_f32 v[26:27], v[18:19], v[22:23]
    v_pk_mul_f32 v[28:29], v[20:21], v[24:25]
    v_accvgpr_read_b32 v32, a28
    v_accvgpr_read_b32 v33, a29
    v_accvgpr_read_b32 v34, a30
    v_accvgpr_read_b32 v35, a31
    v_cvt_pk_bf16_f32 v30, v32, v33
    v_cvt_pk_bf16_f32 v31, v34, v35
    s_nop 1
    v_mfma_f32_16x16x16_bf16 v[18:21], v[6:7], v[16:17], 0
    v_mfma_f32_16x16x16_bf16 v[22:25], v[0:1], v[30:31], 0
    s_nop 7
    s_nop 1
    v_pk_fma_f32 v[26:27], v[18:19], v[22:23], v[26:27]
    v_pk_fma_f32 v[28:29], v[20:21], v[24:25], v[28:29]
    v_accvgpr_read_b32 v32, a32
    v_accvgpr_read_b32 v33, a33
    v_accvgpr_read_b32 v34, a34
    v_accvgpr_read_b32 v35, a35
    v_cvt_pk_bf16_f32 v30, v32, v33
    v_cvt_pk_bf16_f32 v31, v34, v35
    s_nop 1
    v_mfma_f32_16x16x16_bf16 v[18:21], v[8:9], v[16:17], 0
    v_mfma_f32_16x16x16_bf16 v[22:25], v[0:1], v[30:31], 0
    s_nop 7
    s_nop 1
    v_pk_fma_f32 v[26:27], v[18:19], v[22:23], v[26:27]
    v_pk_fma_f32 v[28:29], v[20:21], v[24:25], v[28:29]
    v_cvt_pk_bf16_f32 v30, v26, v27
    v_cvt_pk_bf16_f32 v31, v28, v29
    s_nop 1
    v_mfma_f32_16x16x16_bf16 v[18:21], v[2:3], v[30:31], 0
    v_mfma_f32_16x16x16_bf16 v[22:25], v[10:11], v[16:17], 0
    v_add_u32 v26, 12288, v15
    v_lshlrev_b32 v32, 16, v40
    v_and_b32 v33, 0xffff0000, v40
    v_lshlrev_b32 v34, 16, v41
    v_and_b32 v35, 0xffff0000, v41
    s_nop 3
    v_pk_fma_f32 v[32:33], v[18:19], v[22:23], v[32:33]
    v_pk_fma_f32 v[34:35], v[20:21], v[24:25], v[34:35]
    v_cvt_pk_bf16_f32 v30, v32, v33
    v_cvt_pk_bf16_f32 v31, v34, v35
    buffer_store_dwordx2 v[30:31], v26, s[20:23], 0 offen nt
ESKIP_156:
    v_lshlrev_b32 v34, 16, v57
    v_pk_add_f32 v[32:33], v[34:35], v[12:13] op_sel_hi:[0,1] neg_lo:[0,1] neg_hi:[0,1]
    v_cvt_pk_bf16_f32 v34, v32, v33
    v_lshlrev_b32 v32, 16, v34
    v_and_b32 v33, 0xffff0000, v34
    v_pk_mul_f32 v[32:33], v[32:33], v[32:33]
    v_cvt_pk_bf16_f32 v34, v32, v33
    v_lshlrev_b32 v32, 16, v34
    v_and_b32 v33, 0xffff0000, v34
    v_pk_mul_f32 v[32:33], v[32:33], s[58:59]
    v_cvt_pk_bf16_f32 v34, v32, v33
    v_lshlrev_b32 v32, 16, v34
    v_and_b32 v33, 0xffff0000, v34
    v_pk_mul_f32 v[32:33], v[32:33], s[62:63]
    v_exp_f32 v32, v32
    v_exp_f32 v33, v33
    s_nop 0
    v_cvt_pk_bf16_f32 v16, v32, v33
    v_accvgpr_read_b32 v32, a36
    v_accvgpr_read_b32 v33, a37
    v_accvgpr_read_b32 v34, a38
    v_accvgpr_read_b32 v35, a39
    v_cvt_pk_bf16_f32 v30, v32, v33
    v_cvt_pk_bf16_f32 v31, v34, v35
    s_nop 1
    v_mfma_f32_16x16x16_bf16 v[18:21], v[4:5], v[16:17], 0
    v_mfma_f32_16x16x16_bf16 v[22:25], v[0:1], v[30:31], 0
    s_nop 7
    s_nop 1
    v_pk_mul_f32 v[26:27], v[18:19], v[22:23]
    v_pk_mul_f32 v[28:29], v[20:21], v[24:25]
    v_accvgpr_read_b32 v32, a40
    v_accvgpr_read_b32 v33, a41
    v_accvgpr_read_b32 v34, a42
    v_accvgpr_read_b32 v35, a43
    v_cvt_pk_bf16_f32 v30, v32, v33
    v_cvt_pk_bf16_f32 v31, v34, v35
    s_nop 1
    v_mfma_f32_16x16x16_bf16 v[18:21], v[6:7], v[16:17], 0
    v_mfma_f32_16x16x16_bf16 v[22:25], v[0:1], v[30:31], 0
    s_nop 7
    s_nop 1
    v_pk_fma_f32 v[26:27], v[18:19], v[22:23], v[26:27]
    v_pk_fma_f32 v[28:29], v[20:21], v[24:25], v[28:29]
    v_accvgpr_read_b32 v32, a44
    v_accvgpr_read_b32 v33, a45
    v_accvgpr_read_b32 v34, a46
    v_accvgpr_read_b32 v35, a47
    v_cvt_pk_bf16_f32 v30, v32, v33
    v_cvt_pk_bf16_f32 v31, v34, v35
    s_nop 1
    v_mfma_f32_16x16x16_bf16 v[18:21], v[8:9], v[16:17], 0
    v_mfma_f32_16x16x16_bf16 v[22:25], v[0:1], v[30:31], 0
    s_nop 7
    s_nop 1
    v_pk_fma_f32 v[26:27], v[18:19], v[22:23], v[26:27]
    v_pk_fma_f32 v[28:29], v[20:21], v[24:25], v[28:29]
    v_cvt_pk_bf16_f32 v30, v26, v27
    v_cvt_pk_bf16_f32 v31, v28, v29
    s_nop 1
    v_mfma_f32_16x16x16_bf16 v[18:21], v[2:3], v[30:31], 0
    v_mfma_f32_16x16x16_bf16 v[22:25], v[10:11], v[16:17], 0
    v_add_u32 v26, 18432, v15
    v_lshlrev_b32 v32, 16, v42
    v_and_b32 v33, 0xffff0000, v42
    v_lshlrev_b32 v34, 16, v43
    v_and_b32 v35, 0xffff0000, v43
    s_nop 3
    v_pk_fma_f32 v[32:33], v[18:19], v[22:23], v[32:33]
    v_pk_fma_f32 v[34:35], v[20:21], v[24:25], v[34:35]
    v_cvt_pk_bf16_f32 v30, v32, v33
    v_cvt_pk_bf16_f32 v31, v34, v35
    buffer_store_dwordx2 v[30:31], v26, s[20:23], 0 offen nt
ESKIP_157:
    v_lshlrev_b32 v34, 16, v58
    v_pk_add_f32 v[32:33], v[34:35], v[12:13] op_sel_hi:[0,1] neg_lo:[0,1] neg_hi:[0,1]
    v_cvt_pk_bf16_f32 v34, v32, v33
    v_lshlrev_b32 v32, 16, v34
    v_and_b32 v33, 0xffff0000, v34
    v_pk_mul_f32 v[32:33], v[32:33], v[32:33]
    v_cvt_pk_bf16_f32 v34, v32, v33
    v_lshlrev_b32 v32, 16, v34
    v_and_b32 v33, 0xffff0000, v34
    v_pk_mul_f32 v[32:33], v[32:33], s[58:59]
    v_cvt_pk_bf16_f32 v34, v32, v33
    v_lshlrev_b32 v32, 16, v34
    v_and_b32 v33, 0xffff0000, v34
    v_pk_mul_f32 v[32:33], v[32:33], s[62:63]
    v_exp_f32 v32, v32
    v_exp_f32 v33, v33
    s_nop 0
    v_cvt_pk_bf16_f32 v16, v32, v33
    v_accvgpr_read_b32 v32, a48
    v_accvgpr_read_b32 v33, a49
    v_accvgpr_read_b32 v34, a50
    v_accvgpr_read_b32 v35, a51
    v_cvt_pk_bf16_f32 v30, v32, v33
    v_cvt_pk_bf16_f32 v31, v34, v35
    s_nop 1
    v_mfma_f32_16x16x16_bf16 v[18:21], v[4:5], v[16:17], 0
    v_mfma_f32_16x16x16_bf16 v[22:25], v[0:1], v[30:31], 0
    s_nop 7
    s_nop 1
    v_pk_mul_f32 v[26:27], v[18:19], v[22:23]
    v_pk_mul_f32 v[28:29], v[20:21], v[24:25]
    v_accvgpr_read_b32 v32, a52
    v_accvgpr_read_b32 v33, a53
    v_accvgpr_read_b32 v34, a54
    v_accvgpr_read_b32 v35, a55
    v_cvt_pk_bf16_f32 v30, v32, v33
    v_cvt_pk_bf16_f32 v31, v34, v35
    s_nop 1
    v_mfma_f32_16x16x16_bf16 v[18:21], v[6:7], v[16:17], 0
    v_mfma_f32_16x16x16_bf16 v[22:25], v[0:1], v[30:31], 0
    s_nop 7
    s_nop 1
    v_pk_fma_f32 v[26:27], v[18:19], v[22:23], v[26:27]
    v_pk_fma_f32 v[28:29], v[20:21], v[24:25], v[28:29]
    v_accvgpr_read_b32 v32, a56
    v_accvgpr_read_b32 v33, a57
    v_accvgpr_read_b32 v34, a58
    v_accvgpr_read_b32 v35, a59
    v_cvt_pk_bf16_f32 v30, v32, v33
    v_cvt_pk_bf16_f32 v31, v34, v35
    s_nop 1
    v_mfma_f32_16x16x16_bf16 v[18:21], v[8:9], v[16:17], 0
    v_mfma_f32_16x16x16_bf16 v[22:25], v[0:1], v[30:31], 0
    s_nop 7
    s_nop 1
    v_pk_fma_f32 v[26:27], v[18:19], v[22:23], v[26:27]
    v_pk_fma_f32 v[28:29], v[20:21], v[24:25], v[28:29]
    v_cvt_pk_bf16_f32 v30, v26, v27
    v_cvt_pk_bf16_f32 v31, v28, v29
    s_nop 1
    v_mfma_f32_16x16x16_bf16 v[18:21], v[2:3], v[30:31], 0
    v_mfma_f32_16x16x16_bf16 v[22:25], v[10:11], v[16:17], 0
    v_add_u32 v26, 24576, v15
    v_lshlrev_b32 v32, 16, v44
    v_and_b32 v33, 0xffff0000, v44
    v_lshlrev_b32 v34, 16, v45
    v_and_b32 v35, 0xffff0000, v45
    s_nop 3
    v_pk_fma_f32 v[32:33], v[18:19], v[22:23], v[32:33]
    v_pk_fma_f32 v[34:35], v[20:21], v[24:25], v[34:35]
    v_cvt_pk_bf16_f32 v30, v32, v33
    v_cvt_pk_bf16_f32 v31, v34, v35
    buffer_store_dwordx2 v[30:31], v26, s[20:23], 0 offen nt
ESKIP_158:
    v_lshlrev_b32 v34, 16, v59
    v_pk_add_f32 v[32:33], v[34:35], v[12:13] op_sel_hi:[0,1] neg_lo:[0,1] neg_hi:[0,1]
    v_cvt_pk_bf16_f32 v34, v32, v33
    v_lshlrev_b32 v32, 16, v34
    v_and_b32 v33, 0xffff0000, v34
    v_pk_mul_f32 v[32:33], v[32:33], v[32:33]
    v_cvt_pk_bf16_f32 v34, v32, v33
    v_lshlrev_b32 v32, 16, v34
    v_and_b32 v33, 0xffff0000, v34
    v_pk_mul_f32 v[32:33], v[32:33], s[58:59]
    v_cvt_pk_bf16_f32 v34, v32, v33
    v_lshlrev_b32 v32, 16, v34
    v_and_b32 v33, 0xffff0000, v34
    v_pk_mul_f32 v[32:33], v[32:33], s[62:63]
    v_exp_f32 v32, v32
    v_exp_f32 v33, v33
    s_nop 0
    v_cvt_pk_bf16_f32 v16, v32, v33
    v_accvgpr_read_b32 v32, a60
    v_accvgpr_read_b32 v33, a61
    v_accvgpr_read_b32 v34, a62
    v_accvgpr_read_b32 v35, a63
    v_cvt_pk_bf16_f32 v30, v32, v33
    v_cvt_pk_bf16_f32 v31, v34, v35
    s_nop 1
    v_mfma_f32_16x16x16_bf16 v[18:21], v[4:5], v[16:17], 0
    v_mfma_f32_16x16x16_bf16 v[22:25], v[0:1], v[30:31], 0
    s_nop 7
    s_nop 1
    v_pk_mul_f32 v[26:27], v[18:19], v[22:23]
    v_pk_mul_f32 v[28:29], v[20:21], v[24:25]
    v_accvgpr_read_b32 v32, a64
    v_accvgpr_read_b32 v33, a65
    v_accvgpr_read_b32 v34, a66
    v_accvgpr_read_b32 v35, a67
    v_cvt_pk_bf16_f32 v30, v32, v33
    v_cvt_pk_bf16_f32 v31, v34, v35
    s_nop 1
    v_mfma_f32_16x16x16_bf16 v[18:21], v[6:7], v[16:17], 0
    v_mfma_f32_16x16x16_bf16 v[22:25], v[0:1], v[30:31], 0
    s_nop 7
    s_nop 1
    v_pk_fma_f32 v[26:27], v[18:19], v[22:23], v[26:27]
    v_pk_fma_f32 v[28:29], v[20:21], v[24:25], v[28:29]
    v_accvgpr_read_b32 v32, a68
    v_accvgpr_read_b32 v33, a69
    v_accvgpr_read_b32 v34, a70
    v_accvgpr_read_b32 v35, a71
    v_cvt_pk_bf16_f32 v30, v32, v33
    v_cvt_pk_bf16_f32 v31, v34, v35
    s_nop 1
    v_mfma_f32_16x16x16_bf16 v[18:21], v[8:9], v[16:17], 0
    v_mfma_f32_16x16x16_bf16 v[22:25], v[0:1], v[30:31], 0
    s_nop 7
    s_nop 1
    v_pk_fma_f32 v[26:27], v[18:19], v[22:23], v[26:27]
    v_pk_fma_f32 v[28:29], v[20:21], v[24:25], v[28:29]
    v_cvt_pk_bf16_f32 v30, v26, v27
    v_cvt_pk_bf16_f32 v31, v28, v29
    s_nop 1
    v_mfma_f32_16x16x16_bf16 v[18:21], v[2:3], v[30:31], 0
    v_mfma_f32_16x16x16_bf16 v[22:25], v[10:11], v[16:17], 0
    v_add_u32 v26, 30720, v15
    v_lshlrev_b32 v32, 16, v46
    v_and_b32 v33, 0xffff0000, v46
    v_lshlrev_b32 v34, 16, v47
    v_and_b32 v35, 0xffff0000, v47
    s_nop 3
    v_pk_fma_f32 v[32:33], v[18:19], v[22:23], v[32:33]
    v_pk_fma_f32 v[34:35], v[20:21], v[24:25], v[34:35]
    v_cvt_pk_bf16_f32 v30, v32, v33
    v_cvt_pk_bf16_f32 v31, v34, v35
    buffer_store_dwordx2 v[30:31], v26, s[20:23], 0 offen nt
ESKIP_159:
    s_waitcnt vmcnt(5)
    v_lshlrev_b32 v34, 16, v54
    v_pk_add_f32 v[32:33], v[34:35], v[12:13] op_sel_hi:[0,1] neg_lo:[0,1] neg_hi:[0,1]
    v_cvt_pk_bf16_f32 v34, v32, v33
    v_lshlrev_b32 v32, 16, v34
    v_and_b32 v33, 0xffff0000, v34
    v_pk_mul_f32 v[32:33], v[32:33], v[32:33]
    v_cvt_pk_bf16_f32 v34, v32, v33
    v_lshlrev_b32 v32, 16, v34
    v_and_b32 v33, 0xffff0000, v34
    v_pk_mul_f32 v[32:33], v[32:33], s[58:59]
    v_cvt_pk_bf16_f32 v34, v32, v33
    v_lshlrev_b32 v32, 16, v34
    v_and_b32 v33, 0xffff0000, v34
    v_pk_mul_f32 v[32:33], v[32:33], s[62:63]
    v_exp_f32 v32, v32
    v_exp_f32 v33, v33
    s_nop 0
    v_cvt_pk_bf16_f32 v16, v32, v33
    v_accvgpr_read_b32 v32, a72
    v_accvgpr_read_b32 v33, a73
    v_accvgpr_read_b32 v34, a74
    v_accvgpr_read_b32 v35, a75
    v_cvt_pk_bf16_f32 v30, v32, v33
    v_cvt_pk_bf16_f32 v31, v34, v35
    s_nop 1
    v_mfma_f32_16x16x16_bf16 v[18:21], v[4:5], v[16:17], 0
    v_mfma_f32_16x16x16_bf16 v[22:25], v[0:1], v[30:31], 0
    s_nop 7
    s_nop 1
    v_pk_mul_f32 v[26:27], v[18:19], v[22:23]
    v_pk_mul_f32 v[28:29], v[20:21], v[24:25]
    v_accvgpr_read_b32 v32, a76
    v_accvgpr_read_b32 v33, a77
    v_accvgpr_read_b32 v34, a78
    v_accvgpr_read_b32 v35, a79
    v_cvt_pk_bf16_f32 v30, v32, v33
    v_cvt_pk_bf16_f32 v31, v34, v35
    s_nop 1
    v_mfma_f32_16x16x16_bf16 v[18:21], v[6:7], v[16:17], 0
    v_mfma_f32_16x16x16_bf16 v[22:25], v[0:1], v[30:31], 0
    s_nop 7
    s_nop 1
    v_pk_fma_f32 v[26:27], v[18:19], v[22:23], v[26:27]
    v_pk_fma_f32 v[28:29], v[20:21], v[24:25], v[28:29]
    v_accvgpr_read_b32 v32, a80
    v_accvgpr_read_b32 v33, a81
    v_accvgpr_read_b32 v34, a82
    v_accvgpr_read_b32 v35, a83
    v_cvt_pk_bf16_f32 v30, v32, v33
    v_cvt_pk_bf16_f32 v31, v34, v35
    s_nop 1
    v_mfma_f32_16x16x16_bf16 v[18:21], v[8:9], v[16:17], 0
    v_mfma_f32_16x16x16_bf16 v[22:25], v[0:1], v[30:31], 0
    s_nop 7
    s_nop 1
    v_pk_fma_f32 v[26:27], v[18:19], v[22:23], v[26:27]
    v_pk_fma_f32 v[28:29], v[20:21], v[24:25], v[28:29]
    v_cvt_pk_bf16_f32 v30, v26, v27
    v_cvt_pk_bf16_f32 v31, v28, v29
    s_nop 1
    v_mfma_f32_16x16x16_bf16 v[18:21], v[2:3], v[30:31], 0
    v_mfma_f32_16x16x16_bf16 v[22:25], v[10:11], v[16:17], 0
    v_add_u32 v26, 36864, v15
    v_lshlrev_b32 v32, 16, v48
    v_and_b32 v33, 0xffff0000, v48
    v_lshlrev_b32 v34, 16, v49
    v_and_b32 v35, 0xffff0000, v49
    s_nop 3
    v_pk_fma_f32 v[32:33], v[18:19], v[22:23], v[32:33]
    v_pk_fma_f32 v[34:35], v[20:21], v[24:25], v[34:35]
    v_cvt_pk_bf16_f32 v30, v32, v33
    v_cvt_pk_bf16_f32 v31, v34, v35
    buffer_store_dwordx2 v[30:31], v26, s[20:23], 0 offen nt
ESKIP_160:
    s_waitcnt vmcnt(5)
    v_lshlrev_b32 v34, 16, v55
    v_pk_add_f32 v[32:33], v[34:35], v[12:13] op_sel_hi:[0,1] neg_lo:[0,1] neg_hi:[0,1]
    v_cvt_pk_bf16_f32 v34, v32, v33
    v_lshlrev_b32 v32, 16, v34
    v_and_b32 v33, 0xffff0000, v34
    v_pk_mul_f32 v[32:33], v[32:33], v[32:33]
    v_cvt_pk_bf16_f32 v34, v32, v33
    v_lshlrev_b32 v32, 16, v34
    v_and_b32 v33, 0xffff0000, v34
    v_pk_mul_f32 v[32:33], v[32:33], s[58:59]
    v_cvt_pk_bf16_f32 v34, v32, v33
    v_lshlrev_b32 v32, 16, v34
    v_and_b32 v33, 0xffff0000, v34
    v_pk_mul_f32 v[32:33], v[32:33], s[62:63]
    v_exp_f32 v32, v32
    v_exp_f32 v33, v33
    s_nop 0
    v_cvt_pk_bf16_f32 v16, v32, v33
    v_accvgpr_read_b32 v32, a84
    v_accvgpr_read_b32 v33, a85
    v_accvgpr_read_b32 v34, a86
    v_accvgpr_read_b32 v35, a87
    v_cvt_pk_bf16_f32 v30, v32, v33
    v_cvt_pk_bf16_f32 v31, v34, v35
    s_nop 1
    v_mfma_f32_16x16x16_bf16 v[18:21], v[4:5], v[16:17], 0
    v_mfma_f32_16x16x16_bf16 v[22:25], v[0:1], v[30:31], 0
    s_nop 7
    s_nop 1
    v_pk_mul_f32 v[26:27], v[18:19], v[22:23]
    v_pk_mul_f32 v[28:29], v[20:21], v[24:25]
    v_accvgpr_read_b32 v32, a88
    v_accvgpr_read_b32 v33, a89
    v_accvgpr_read_b32 v34, a90
    v_accvgpr_read_b32 v35, a91
    v_cvt_pk_bf16_f32 v30, v32, v33
    v_cvt_pk_bf16_f32 v31, v34, v35
    s_nop 1
    v_mfma_f32_16x16x16_bf16 v[18:21], v[6:7], v[16:17], 0
    v_mfma_f32_16x16x16_bf16 v[22:25], v[0:1], v[30:31], 0
    s_nop 7
    s_nop 1
    v_pk_fma_f32 v[26:27], v[18:19], v[22:23], v[26:27]
    v_pk_fma_f32 v[28:29], v[20:21], v[24:25], v[28:29]
    v_accvgpr_read_b32 v32, a92
    v_accvgpr_read_b32 v33, a93
    v_accvgpr_read_b32 v34, a94
    v_accvgpr_read_b32 v35, a95
    v_cvt_pk_bf16_f32 v30, v32, v33
    v_cvt_pk_bf16_f32 v31, v34, v35
    s_nop 1
    v_mfma_f32_16x16x16_bf16 v[18:21], v[8:9], v[16:17], 0
    v_mfma_f32_16x16x16_bf16 v[22:25], v[0:1], v[30:31], 0
    s_nop 7
    s_nop 1
    v_pk_fma_f32 v[26:27], v[18:19], v[22:23], v[26:27]
    v_pk_fma_f32 v[28:29], v[20:21], v[24:25], v[28:29]
    v_cvt_pk_bf16_f32 v30, v26, v27
    v_cvt_pk_bf16_f32 v31, v28, v29
    s_nop 1
    v_mfma_f32_16x16x16_bf16 v[18:21], v[2:3], v[30:31], 0
    v_mfma_f32_16x16x16_bf16 v[22:25], v[10:11], v[16:17], 0
    v_add_u32 v26, 43008, v15
    v_lshlrev_b32 v32, 16, v50
    v_and_b32 v33, 0xffff0000, v50
    v_lshlrev_b32 v34, 16, v51
    v_and_b32 v35, 0xffff0000, v51
    s_nop 3
    v_pk_fma_f32 v[32:33], v[18:19], v[22:23], v[32:33]
    v_pk_fma_f32 v[34:35], v[20:21], v[24:25], v[34:35]
    v_cvt_pk_bf16_f32 v30, v32, v33
    v_cvt_pk_bf16_f32 v31, v34, v35
    buffer_store_dwordx2 v[30:31], v26, s[20:23], 0 offen nt
ESKIP_161:
    s_cmp_ge_u32 s3, 2
    s_cbranch_scc1 ESKIP_162
    s_waitcnt vmcnt(5)
    v_lshlrev_b32 v34, 16, v56
    v_pk_add_f32 v[32:33], v[34:35], v[12:13] op_sel_hi:[0,1] neg_lo:[0,1] neg_hi:[0,1]
    v_cvt_pk_bf16_f32 v34, v32, v33
    v_lshlrev_b32 v32, 16, v34
    v_and_b32 v33, 0xffff0000, v34
    v_pk_mul_f32 v[32:33], v[32:33], v[32:33]
    v_cvt_pk_bf16_f32 v34, v32, v33
    v_lshlrev_b32 v32, 16, v34
    v_and_b32 v33, 0xffff0000, v34
    v_pk_mul_f32 v[32:33], v[32:33], s[58:59]
    v_cvt_pk_bf16_f32 v34, v32, v33
    v_lshlrev_b32 v32, 16, v34
    v_and_b32 v33, 0xffff0000, v34
    v_pk_mul_f32 v[32:33], v[32:33], s[62:63]
    v_exp_f32 v32, v32
    v_exp_f32 v33, v33
    s_nop 0
    v_cvt_pk_bf16_f32 v16, v32, v33
    v_accvgpr_read_b32 v32, a96
    v_accvgpr_read_b32 v33, a97
    v_accvgpr_read_b32 v34, a98
    v_accvgpr_read_b32 v35, a99
    v_cvt_pk_bf16_f32 v30, v32, v33
    v_cvt_pk_bf16_f32 v31, v34, v35
    s_nop 1
    v_mfma_f32_16x16x16_bf16 v[18:21], v[4:5], v[16:17], 0
    v_mfma_f32_16x16x16_bf16 v[22:25], v[0:1], v[30:31], 0
    s_nop 7
    s_nop 1
    v_pk_mul_f32 v[26:27], v[18:19], v[22:23]
    v_pk_mul_f32 v[28:29], v[20:21], v[24:25]
    v_accvgpr_read_b32 v32, a100
    v_accvgpr_read_b32 v33, a101
    v_accvgpr_read_b32 v34, a102
    v_accvgpr_read_b32 v35, a103
    v_cvt_pk_bf16_f32 v30, v32, v33
    v_cvt_pk_bf16_f32 v31, v34, v35
    s_nop 1
    v_mfma_f32_16x16x16_bf16 v[18:21], v[6:7], v[16:17], 0
    v_mfma_f32_16x16x16_bf16 v[22:25], v[0:1], v[30:31], 0
    s_nop 7
    s_nop 1
    v_pk_fma_f32 v[26:27], v[18:19], v[22:23], v[26:27]
    v_pk_fma_f32 v[28:29], v[20:21], v[24:25], v[28:29]
    v_accvgpr_read_b32 v32, a104
    v_accvgpr_read_b32 v33, a105
    v_accvgpr_read_b32 v34, a106
    v_accvgpr_read_b32 v35, a107
    v_cvt_pk_bf16_f32 v30, v32, v33
    v_cvt_pk_bf16_f32 v31, v34, v35
    s_nop 1
    v_mfma_f32_16x16x16_bf16 v[18:21], v[8:9], v[16:17], 0
    v_mfma_f32_16x16x16_bf16 v[22:25], v[0:1], v[30:31], 0
    s_nop 7
    s_nop 1
    v_pk_fma_f32 v[26:27], v[18:19], v[22:23], v[26:27]
    v_pk_fma_f32 v[28:29], v[20:21], v[24:25], v[28:29]
    v_cvt_pk_bf16_f32 v30, v26, v27
    v_cvt_pk_bf16_f32 v31, v28, v29
    s_nop 1
    v_mfma_f32_16x16x16_bf16 v[18:21], v[2:3], v[30:31], 0
    v_mfma_f32_16x16x16_bf16 v[22:25], v[10:11], v[16:17], 0
    v_add_u32 v26, 49152, v15
    v_cndmask_b32_e64 v26, -16, v26, s[56:57]
    v_lshlrev_b32 v32, 16, v52
    v_and_b32 v33, 0xffff0000, v52
    v_lshlrev_b32 v34, 16, v53
    v_and_b32 v35, 0xffff0000, v53
    s_nop 3
    v_pk_fma_f32 v[32:33], v[18:19], v[22:23], v[32:33]
    v_pk_fma_f32 v[34:35], v[20:21], v[24:25], v[34:35]
    v_cvt_pk_bf16_f32 v30, v32, v33
    v_cvt_pk_bf16_f32 v31, v34, v35
    buffer_store_dwordx2 v[30:31], v26, s[20:23], 0 offen nt
ESKIP_162:
P2_END:
    s_endpgm
.section .rodata,"a"
.p2align 6
.amdhsa_kernel gemnet_part_kernel
  .amdhsa_next_free_vgpr 128
  .amdhsa_next_free_sgpr 80
  .amdhsa_accum_offset 128
  .amdhsa_group_segment_fixed_size 0
  .amdhsa_kernarg_size 112
  .amdhsa_user_sgpr_count 2
  .amdhsa_user_sgpr_kernarg_segment_ptr 1
  .amdhsa_system_sgpr_workgroup_id_x 1
  .amdhsa_float_denorm_mode_32 3
  .amdhsa_float_denorm_mode_16_64 3
.end_amdhsa_kernel
.p2align 6
.amdhsa_kernel standalone__molecular_angular_gemnet__graph_kernel
  .amdhsa_next_free_vgpr 168
  .amdhsa_next_free_sgpr 102
  .amdhsa_accum_offset 60
  .amdhsa_group_segment_fixed_size 0
  .amdhsa_kernarg_size 112
  .amdhsa_user_sgpr_count 2
  .amdhsa_user_sgpr_kernarg_segment_ptr 1
  .amdhsa_system_sgpr_workgroup_id_x 1
  .amdhsa_float_denorm_mode_32 3
  .amdhsa_float_denorm_mode_16_64 3
.end_amdhsa_kernel
```
